```python
import torch

def _softmax(x, axis=-1):
    return torch.softmax(x, dim=axis)
def _gelu(x):
    return torch.nn.functional.gelu(x, approximate="tanh")
def _silu(x):
    return torch.nn.functional.silu(x)
def _sigmoid(x):
    return torch.sigmoid(x)
def _layernorm(x, axis=-1, eps=1e-5):
    m = x.mean(dim=axis, keepdim=True)
    v = x.var(dim=axis, keepdim=True, unbiased=False)
    return (x - m) / torch.sqrt(v + eps)
def _scatter_add(tgt, idx, src, axis=0):
    return tgt.clone().index_add_(axis, idx, src)
def _segment_sum(src, seg, n):
    out = torch.zeros((n,) + src.shape[1:], dtype=src.dtype)
    return out.index_add_(0, seg, src)
def _pad(x, pw):
    flat = tuple(v for pair in reversed(pw) for v in pair)
    return torch.nn.functional.pad(x, flat)

kernel_name = 'parallel_sum__compressed_kv_cla__dense_activation_squared_relu__decode'

def setup_inputs():

    _w = (lambda a: (lambda t: t.to(torch.bfloat16) if t.is_floating_point() else t)(torch.as_tensor(a)))
    def _A_setup():
        B, H, Sq, Sk, D, M = 1, 32, 1, 16384, 128, 512
        Dc = 4 * D
        return {
            "x": _w((lambda *s: torch.randn(*s, dtype=torch.bfloat16) * 0.05)(B, Sq, M)),
            "c_kv": _w((lambda *s: torch.randn(*s, dtype=torch.bfloat16) * 3.2)(B, Sk, Dc)),
            "w_q": _w((lambda *s: torch.randn(*s, dtype=torch.bfloat16) * 1.6)(M, H, D) * (M ** -0.5)),
            "w_uk": _w((lambda *s: torch.randn(*s, dtype=torch.bfloat16) * 1.6)(Dc, H, D) * (Dc ** -0.5)),
            "w_uv": _w((lambda *s: torch.randn(*s, dtype=torch.bfloat16) * 3.2)(Dc, H, D) * (Dc ** -0.5)),
            "w_o": _w((lambda *s: torch.randn(*s, dtype=torch.bfloat16) * 3.2)(H, D, M) * ((H * D) ** -0.5)),
        }
    _A_in = _A_setup()

    def _B_setup():
        B, S, D, F = 1, 1, 512, 1792
        return {
            "x": _w((lambda *s: torch.randn(*s, dtype=torch.bfloat16) * 0.05)(B, S, D)),
            "w1": _w((lambda *s: torch.randn(*s, dtype=torch.bfloat16) * 0.1)(D, F)),
            "b1": _w((lambda *s: torch.randn(*s, dtype=torch.bfloat16) * 0.8)(F)),
            "w2": _w((lambda *s: torch.randn(*s, dtype=torch.bfloat16) * 0.1)(F, D)),
            "b2": _w((lambda *s: torch.randn(*s, dtype=torch.bfloat16) * 12.8)(D)),
        }
    _B_in = _B_setup()

    return {
        "A_x": _A_in["x"],
        "A_c_kv": _A_in["c_kv"],
        "A_w_q": _A_in["w_q"],
        "A_w_uk": _A_in["w_uk"],
        "A_w_uv": _A_in["w_uv"],
        "A_w_o": _A_in["w_o"],
        "B_x": _B_in["x"],
        "B_w1": _B_in["w1"],
        "B_b1": _B_in["b1"],
        "B_w2": _B_in["w2"],
        "B_b2": _B_in["b2"],
    }

def reference(A_x, A_c_kv, A_w_q, A_w_uk, A_w_uv, A_w_o, B_x, B_w1, B_b1, B_w2, B_b2):
    def _A_ref(x, c_kv, w_q, w_uk, w_uv, w_o):
        B, Sq, M = x.shape[0], x.shape[1], x.shape[2]
        Sk = c_kv.shape[1]
        H, D = w_q.shape[1], w_q.shape[2]
        q = torch.einsum("bqm,mhd->bhqd", x, w_q)
        k = torch.einsum("bkc,chd->bhkd", c_kv, w_uk)
        v = torch.einsum("bkc,chd->bhkd", c_kv, w_uv)
        scores = torch.einsum("bhqd,bhkd->bhqk", q, k) * (D ** -0.5)
        off = Sk - Sq
        qi = torch.arange(Sq)[:, None]
        kj = torch.arange(Sk)[None, :]
        cmask = kj <= (qi + off)
        scores = torch.where(cmask[None, None], scores, -1e9)
        p = _softmax(scores, axis=-1)
        ctx = torch.einsum("bhqk,bhkd->bhqd", p, v)
        return torch.einsum("bhqd,hdm->bqm", ctx, w_o)

    def _B_ref(x, w1, b1, w2, b2):
        h = torch.einsum("bsd,df->bsf", x, w1) + b1
        zero = torch.zeros_like(h)
        r = torch.where(h > zero, h, zero)
        h = r * r
        out = torch.einsum("bsf,fd->bsd", h, w2) + b2
        return out

    x = A_x
    xn = _layernorm(x, axis=-1)
    return x + _A_ref(xn, A_c_kv, A_w_q, A_w_uk, A_w_uv, A_w_o) + _B_ref(xn, B_w1, B_b1, B_w2, B_b2)
```

```asm
; @launch grid=(256,1,1) block=(512,1,1) lds=158784
.amdgcn_target "amdgcn-amd-amdhsa--gfx950"
.text
.globl parallel_sum__compressed_kv_cla__dense_activation_squared_relu__decode_kernel
.p2align 8
.type parallel_sum__compressed_kv_cla__dense_activation_squared_relu__decode_kernel,@function
parallel_sum__compressed_kv_cla__dense_activation_squared_relu__decode_kernel:
L_start:
    s_load_dwordx16 s[4:19], s[0:1], 0
    s_load_dwordx4 s[28:31], s[0:1], 96
    s_getpc_b64 s[48:49]
L_pc:
    s_cmpk_ge_u32 s2, 0x100
    s_cbranch_scc1 L_end
    v_lshrrev_b32 v4, 5, v0
    s_lshl_b32 s43, s2, 8
    v_readfirstlane_b32 s3, v4
    s_and_b32 s43, s43, 0x7800
    v_lshl_add_u32 v4, v4, 7, s43
    v_min_u32 v4, L_end-L_pc, v4
    s_mov_b32 exec_lo, 1
    s_mov_b32 exec_hi, 1
    global_load_dword v15, v4, s[48:49]
    s_mov_b64 exec, -1
    s_cmp_ge_u32 s3, 8
    s_cbranch_scc1 L_S
    s_cmp_eq_u32 s3, 2
    s_cbranch_scc1 L_F1
    s_cmp_lg_u32 s3, 0
    s_cbranch_scc1 L_F23
    v_lshrrev_b32 v2, 4, v0
    s_and_b32 s32, s2, 7
    v_and_b32 v1, 15, v0
    s_lshr_b32 s33, s2, 3
    v_lshl_add_u32 v5, s32, 2, v2
    v_lshl_add_u32 v5, v5, 9, s33
    v_lshl_add_u32 v5, v5, 4, v1
    v_lshlrev_b32 v3, 4, v0
    v_lshlrev_b32 v5, 4, v5
    s_movk_i32 s44, 0x4000
    s_waitcnt lgkmcnt(0)
    global_load_dwordx4 v[120:123], v3, s[4:5]
    s_add_u32 s16, s8, 0x2000
    s_addc_u32 s17, s9, 0
    global_load_dwordx4 v[128:131], v5, s[8:9] nt
    global_load_dwordx4 v[132:135], v5, s[16:17] nt
    v_add_u32 v5, s44, v5
    global_load_dwordx4 v[136:139], v5, s[8:9] nt
    global_load_dwordx4 v[140:143], v5, s[16:17] nt
    v_add_u32 v5, s44, v5
    global_load_dwordx4 v[144:147], v5, s[8:9] nt
    global_load_dwordx4 v[148:151], v5, s[16:17] nt
    v_add_u32 v5, s44, v5
    global_load_dwordx4 v[152:155], v5, s[8:9] nt
    global_load_dwordx4 v[156:159], v5, s[16:17] nt
    v_add_u32 v5, s44, v5
    global_load_dwordx4 v[160:163], v5, s[8:9] nt
    global_load_dwordx4 v[164:167], v5, s[16:17] nt
    v_add_u32 v5, s44, v5
    global_load_dwordx4 v[168:171], v5, s[8:9] nt
    global_load_dwordx4 v[172:175], v5, s[16:17] nt
    v_add_u32 v5, s44, v5
    global_load_dwordx4 v[176:179], v5, s[8:9] nt
    global_load_dwordx4 v[180:183], v5, s[16:17] nt
    v_add_u32 v5, s44, v5
    global_load_dwordx4 v[184:187], v5, s[8:9] nt
    global_load_dwordx4 v[188:191], v5, s[16:17] nt
    s_load_dwordx8 s[20:27], s[0:1], 64
    s_lshr_b32 s3, s3, 1
    s_lshr_b32 s35, s33, 4
    s_xor_b32 s35, s35, 1
    s_and_b32 s42, s33, 15
    s_lshl4_add_u32 s36, s32, s42
    s_and_b32 s47, s3, 3
    v_mov_b32 v13, 158720
    v_mov_b32 v14, 1
    s_mov_b32 s34, 0x1000000
    s_waitcnt lgkmcnt(0)
    s_load_dword s41, s[30:31], 0
    s_lshl_b32 s42, s2, 9
    s_add_u32 s42, s42, 4096
    v_add_u32 v12, s42, v3
    v_mov_b32 v92, 0
    v_mov_b32 v93, 0
    v_mov_b32 v94, 0
    v_mov_b32 v95, 0
    s_mov_b32 exec_hi, 0
    global_store_dwordx4 v12, v[92:95], s[30:31] sc1
    s_mov_b64 exec, -1
    v_and_b32 v6, 1, v1
    v_cmp_eq_u32 vcc, 1, v6
    v_mov_b32 v7, 0x0c0c0100
    v_mov_b32 v8, 0x01000c0c
    v_cndmask_b32 v7, v7, v8, vcc
    v_mov_b32 v8, 0x0c0c0302
    v_mov_b32 v9, 0x03020c0c
    v_cndmask_b32 v8, v8, v9, vcc
    v_mov_b32 v9, 0x0c0c0c0c
    v_bfe_u32 v6, v1, 1, 2
    v_cmp_eq_u32 vcc, 0, v6
    s_nop 1
    v_cndmask_b32 v32, v9, v7, vcc
    v_cndmask_b32 v36, v9, v8, vcc
    v_cmp_eq_u32 vcc, 1, v6
    s_nop 1
    v_cndmask_b32 v33, v9, v7, vcc
    v_cndmask_b32 v37, v9, v8, vcc
    v_cmp_eq_u32 vcc, 2, v6
    s_nop 1
    v_cndmask_b32 v34, v9, v7, vcc
    v_cndmask_b32 v38, v9, v8, vcc
    v_cmp_eq_u32 vcc, 3, v6
    s_nop 1
    v_cndmask_b32 v35, v9, v7, vcc
    v_cndmask_b32 v39, v9, v8, vcc
    v_add_u32 v10, 151552, v3
    s_lshl_b32 s42, s32, 7
    s_add_u32 s42, s42, 151552
    v_lshl_add_u32 v11, v2, 5, s42
    s_lshl_b32 s42, s2, 9
    s_add_u32 s42, s42, 4096
    v_add_u32 v12, s42, v3
    s_mov_b32 s45, 0xffff0000
    s_mov_b32 s58, 0x07060501
    s_mov_b32 s59, 0x07060502
    s_mov_b32 s60, 0x07060503
    s_waitcnt vmcnt(17)
    s_barrier
    v_lshlrev_b32 v96, 16, v120
    v_and_b32 v97, s45, v120
    v_lshlrev_b32 v98, 16, v121
    v_and_b32 v99, s45, v121
    v_lshlrev_b32 v100, 16, v122
    v_and_b32 v101, s45, v122
    v_lshlrev_b32 v102, 16, v123
    v_and_b32 v103, s45, v123
    v_add_f32 v112, v96, v97
    v_add_f32 v113, v98, v99
    v_add_f32 v114, v100, v101
    v_add_f32 v115, v102, v103
    v_add_f32 v112, v112, v113
    v_add_f32 v114, v114, v115
    v_add_f32 v112, v112, v114
    s_nop 1
    v_add_f32 v112, v112, v112 row_ror:8
    s_nop 1
    v_add_f32 v112, v112, v112 row_ror:4
    s_nop 1
    v_add_f32 v112, v112, v112 row_ror:2
    s_nop 1
    v_add_f32 v112, v112, v112 row_ror:1
    s_nop 1
    v_add_f32 v112, v112, v112 row_bcast:15 row_mask:0xa
    s_nop 1
    v_add_f32 v112, v112, v112 row_bcast:31 row_mask:0xc
    v_mov_b32 v113, 0x3b000000
    v_readlane_b32 s42, v112, 63
    s_nop 1
    v_mul_f32 v113, s42, v113
    v_sub_f32 v104, v96, v113
    v_sub_f32 v105, v97, v113
    v_sub_f32 v106, v98, v113
    v_sub_f32 v107, v99, v113
    v_sub_f32 v108, v100, v113
    v_sub_f32 v109, v101, v113
    v_sub_f32 v110, v102, v113
    v_sub_f32 v111, v103, v113
    v_mul_f32 v112, v104, v104
    v_mul_f32 v114, v105, v105
    v_fmac_f32 v112, v106, v106
    v_fmac_f32 v114, v107, v107
    v_fmac_f32 v112, v108, v108
    v_fmac_f32 v114, v109, v109
    v_fmac_f32 v112, v110, v110
    v_fmac_f32 v114, v111, v111
    v_add_f32 v112, v112, v114
    v_cvt_pk_bf16_f32 v113, v113, v113
    v_and_b32 v113, s45, v113
    v_add_f32 v112, v112, v112 row_ror:8
    v_sub_f32 v104, v96, v113
    v_sub_f32 v105, v97, v113
    v_sub_f32 v106, v98, v113
    v_sub_f32 v107, v99, v113
    v_add_f32 v112, v112, v112 row_ror:4
    v_sub_f32 v108, v100, v113
    v_sub_f32 v109, v101, v113
    v_sub_f32 v110, v102, v113
    v_sub_f32 v111, v103, v113
    v_add_f32 v112, v112, v112 row_ror:2
    v_cvt_pk_bf16_f32 v116, v104, v105
    v_cvt_pk_bf16_f32 v117, v106, v107
    v_add_f32 v112, v112, v112 row_ror:1
    v_cvt_pk_bf16_f32 v118, v108, v109
    v_cvt_pk_bf16_f32 v119, v110, v111
    v_add_f32 v112, v112, v112 row_bcast:15 row_mask:0xa
    v_lshlrev_b32 v104, 16, v116
    v_and_b32 v105, s45, v116
    v_lshlrev_b32 v106, 16, v117
    v_and_b32 v107, s45, v117
    v_add_f32 v112, v112, v112 row_bcast:31 row_mask:0xc
    v_lshlrev_b32 v108, 16, v118
    v_and_b32 v109, s45, v118
    v_lshlrev_b32 v110, 16, v119
    v_and_b32 v111, s45, v119
    v_mov_b32 v113, 0x3b000000
    v_readlane_b32 s42, v112, 63
    s_nop 1
    v_mul_f32 v113, s42, v113
    v_cvt_pk_bf16_f32 v113, v113, v113
    v_and_b32 v113, s45, v113
    v_add_f32 v113, 0x3727c5ac, v113
    v_cvt_pk_bf16_f32 v113, v113, v113
    v_and_b32 v113, s45, v113
    v_sqrt_f32 v113, v113
    s_nop 0
    v_cvt_pk_bf16_f32 v113, v113, v113
    v_and_b32 v113, s45, v113
    v_rcp_f32 v113, v113
    s_nop 0
    v_mul_f32 v104, v104, v113
    v_mul_f32 v105, v105, v113
    v_mul_f32 v106, v106, v113
    v_mul_f32 v107, v107, v113
    v_mul_f32 v108, v108, v113
    v_mul_f32 v109, v109, v113
    v_mul_f32 v110, v110, v113
    v_mul_f32 v111, v111, v113
    v_cvt_pk_bf16_f32 v116, v104, v105
    v_cvt_pk_bf16_f32 v117, v106, v107
    v_cvt_pk_bf16_f32 v118, v108, v109
    v_cvt_pk_bf16_f32 v119, v110, v111
    ds_write_b128 v10, v[116:119]
    ds_read_b128 v[80:83], v11
    ds_read_b128 v[84:87], v11 offset:16
    s_waitcnt lgkmcnt(0)
    s_add_u32 s41, s41, 1
    s_addc_u32 s41, s41, 0
    v_perm_b32 v72, v80, v80, v32
    v_perm_b32 v73, v80, v80, v33
    v_perm_b32 v74, v80, v80, v34
    v_perm_b32 v75, v80, v80, v35
    v_perm_b32 v76, v80, v80, v36
    v_perm_b32 v77, v80, v80, v37
    v_perm_b32 v78, v80, v80, v38
    v_perm_b32 v79, v80, v80, v39
    s_waitcnt vmcnt(16)
    v_mfma_f32_16x16x32_bf16 v[88:91], v[72:75], v[128:131], 0
    v_perm_b32 v72, v81, v81, v32
    v_perm_b32 v73, v81, v81, v33
    v_perm_b32 v74, v81, v81, v34
    v_perm_b32 v75, v81, v81, v35
    s_waitcnt vmcnt(15)
    v_mfma_f32_16x16x32_bf16 v[88:91], v[76:79], v[132:135], v[88:91]
    v_perm_b32 v76, v81, v81, v36
    v_perm_b32 v77, v81, v81, v37
    v_perm_b32 v78, v81, v81, v38
    v_perm_b32 v79, v81, v81, v39
    s_waitcnt vmcnt(14)
    v_mfma_f32_16x16x32_bf16 v[88:91], v[72:75], v[136:139], v[88:91]
    v_perm_b32 v72, v82, v82, v32
    v_perm_b32 v73, v82, v82, v33
    v_perm_b32 v74, v82, v82, v34
    v_perm_b32 v75, v82, v82, v35
    s_waitcnt vmcnt(13)
    v_mfma_f32_16x16x32_bf16 v[88:91], v[76:79], v[140:143], v[88:91]
    v_perm_b32 v76, v82, v82, v36
    v_perm_b32 v77, v82, v82, v37
    v_perm_b32 v78, v82, v82, v38
    v_perm_b32 v79, v82, v82, v39
    s_waitcnt vmcnt(12)
    v_mfma_f32_16x16x32_bf16 v[88:91], v[72:75], v[144:147], v[88:91]
    v_perm_b32 v72, v83, v83, v32
    v_perm_b32 v73, v83, v83, v33
    v_perm_b32 v74, v83, v83, v34
    v_perm_b32 v75, v83, v83, v35
    s_waitcnt vmcnt(11)
    v_mfma_f32_16x16x32_bf16 v[88:91], v[76:79], v[148:151], v[88:91]
    v_perm_b32 v76, v83, v83, v36
    v_perm_b32 v77, v83, v83, v37
    v_perm_b32 v78, v83, v83, v38
    v_perm_b32 v79, v83, v83, v39
    s_waitcnt vmcnt(10)
    v_mfma_f32_16x16x32_bf16 v[88:91], v[72:75], v[152:155], v[88:91]
    v_perm_b32 v72, v84, v84, v32
    v_perm_b32 v73, v84, v84, v33
    v_perm_b32 v74, v84, v84, v34
    v_perm_b32 v75, v84, v84, v35
    s_waitcnt vmcnt(9)
    v_mfma_f32_16x16x32_bf16 v[88:91], v[76:79], v[156:159], v[88:91]
    v_perm_b32 v76, v84, v84, v36
    v_perm_b32 v77, v84, v84, v37
    v_perm_b32 v78, v84, v84, v38
    v_perm_b32 v79, v84, v84, v39
    s_waitcnt vmcnt(8)
    v_mfma_f32_16x16x32_bf16 v[88:91], v[72:75], v[160:163], v[88:91]
    v_perm_b32 v72, v85, v85, v32
    v_perm_b32 v73, v85, v85, v33
    v_perm_b32 v74, v85, v85, v34
    v_perm_b32 v75, v85, v85, v35
    s_waitcnt vmcnt(7)
    v_mfma_f32_16x16x32_bf16 v[88:91], v[76:79], v[164:167], v[88:91]
    v_perm_b32 v76, v85, v85, v36
    v_perm_b32 v77, v85, v85, v37
    v_perm_b32 v78, v85, v85, v38
    v_perm_b32 v79, v85, v85, v39
    s_waitcnt vmcnt(6)
    v_mfma_f32_16x16x32_bf16 v[88:91], v[72:75], v[168:171], v[88:91]
    v_perm_b32 v72, v86, v86, v32
    v_perm_b32 v73, v86, v86, v33
    v_perm_b32 v74, v86, v86, v34
    v_perm_b32 v75, v86, v86, v35
    s_waitcnt vmcnt(5)
    v_mfma_f32_16x16x32_bf16 v[88:91], v[76:79], v[172:175], v[88:91]
    v_perm_b32 v76, v86, v86, v36
    v_perm_b32 v77, v86, v86, v37
    v_perm_b32 v78, v86, v86, v38
    v_perm_b32 v79, v86, v86, v39
    s_waitcnt vmcnt(4)
    v_mfma_f32_16x16x32_bf16 v[88:91], v[72:75], v[176:179], v[88:91]
    v_perm_b32 v72, v87, v87, v32
    v_perm_b32 v73, v87, v87, v33
    v_perm_b32 v74, v87, v87, v34
    v_perm_b32 v75, v87, v87, v35
    s_waitcnt vmcnt(3)
    v_mfma_f32_16x16x32_bf16 v[88:91], v[76:79], v[180:183], v[88:91]
    v_perm_b32 v76, v87, v87, v36
    v_perm_b32 v77, v87, v87, v37
    v_perm_b32 v78, v87, v87, v38
    v_perm_b32 v79, v87, v87, v39
    s_waitcnt vmcnt(2)
    v_mfma_f32_16x16x32_bf16 v[88:91], v[72:75], v[184:187], v[88:91]
    v_mov_b32 v94, s41
    v_mov_b32 v95, s41
    s_waitcnt vmcnt(1)
    v_mfma_f32_16x16x32_bf16 v[88:91], v[76:79], v[188:191], v[88:91]
    s_nop 7
    v_perm_b32 v92, v88, v91, s58
    v_perm_b32 v93, v89, v91, s59
    v_perm_b32 v94, v90, v91, s60
    s_mov_b32 exec_hi, 0
    global_store_dwordx4 v12, v[92:95], s[30:31] sc1
    ds_write_b128 v10, v[88:91] offset:3584
    s_mov_b64 exec, 1
    ds_add_u32 v13, v14 offset:0
    s_mov_b64 exec, -1
    s_branch L_QG
L_F1:
    s_load_dwordx8 s[20:27], s[0:1], 64
    v_and_b32 v0, 63, v0
    v_and_b32 v1, 15, v0
    v_lshrrev_b32 v2, 4, v0
    v_lshlrev_b32 v3, 4, v0
    s_and_b32 s32, s2, 7
    s_lshr_b32 s33, s2, 3
    s_lshr_b32 s3, s3, 1
    s_lshr_b32 s35, s33, 4
    s_xor_b32 s35, s35, 1
    s_and_b32 s42, s33, 15
    s_lshl4_add_u32 s36, s32, s42
    s_and_b32 s47, s3, 3
    v_mov_b32 v13, 158720
    v_mov_b32 v14, 1
    s_mov_b32 s34, 0x1000000
    s_lshl_b32 s42, s32, 19
    s_lshl_b32 s43, s33, 8
    s_add_u32 s42, s42, s43
    v_lshlrev_b32 v6, 1, v2
    v_xor_b32 v6, v6, v1
    v_lshlrev_b32 v5, 16, v2
    v_lshl_add_u32 v5, v6, 4, v5
    v_add_u32 v5, s42, v5
    v_xor_b32 v6, 0x80, v5
    v_add_u32 v6, 0x40000, v6
    s_mov_b32 s44, 0x8000
    s_mov_b32 s45, 4294942720
    s_mov_b32 m0, 131072
    s_waitcnt lgkmcnt(0)
    s_load_dword s41, s[30:31], 0
    s_lshl_b32 s43, s2, 7
    s_add_u32 s43, s43, 135168
    v_add_u32 v12, s43, v3
    v_mov_b32 v20, 0
    v_mov_b32 v21, 0
    v_mov_b32 v22, 0
    v_mov_b32 v23, 0
    s_barrier
    s_mov_b64 exec, 0xff
    global_store_dwordx4 v12, v[20:23], s[30:31] sc1
    s_mov_b64 exec, -1
    global_load_lds_dwordx4 v5, s[10:11] nt
    s_add_u32 m0, m0, 0x400
    v_add_u32 v5, s44, v5
    global_load_lds_dwordx4 v6, s[10:11] nt
    s_add_u32 m0, m0, 0x400
    v_add_u32 v6, s44, v6
    global_load_lds_dwordx4 v5, s[10:11] nt
    s_add_u32 m0, m0, 0x400
    v_add_u32 v5, s45, v5
    global_load_lds_dwordx4 v6, s[10:11] nt
    s_add_u32 m0, m0, 0x400
    v_add_u32 v6, s45, v6
    global_load_lds_dwordx4 v5, s[10:11] nt
    s_add_u32 m0, m0, 0x400
    v_add_u32 v5, s44, v5
    global_load_lds_dwordx4 v6, s[10:11] nt
    s_add_u32 m0, m0, 0x400
    v_add_u32 v6, s44, v6
    global_load_lds_dwordx4 v5, s[10:11] nt
    s_add_u32 m0, m0, 0x400
    v_add_u32 v5, s45, v5
    global_load_lds_dwordx4 v6, s[10:11] nt
    s_add_u32 m0, m0, 0x400
    v_add_u32 v6, s45, v6
    global_load_lds_dwordx4 v5, s[10:11] nt
    s_add_u32 m0, m0, 0x400
    v_add_u32 v5, s44, v5
    global_load_lds_dwordx4 v6, s[10:11] nt
    s_add_u32 m0, m0, 0x400
    v_add_u32 v6, s44, v6
    global_load_lds_dwordx4 v5, s[10:11] nt
    s_add_u32 m0, m0, 0x400
    v_add_u32 v5, s45, v5
    global_load_lds_dwordx4 v6, s[10:11] nt
    s_add_u32 m0, m0, 0x400
    v_add_u32 v6, s45, v6
    global_load_lds_dwordx4 v5, s[10:11] nt
    s_add_u32 m0, m0, 0x400
    v_add_u32 v5, s44, v5
    global_load_lds_dwordx4 v6, s[10:11] nt
    s_add_u32 m0, m0, 0x400
    v_add_u32 v6, s44, v6
    global_load_lds_dwordx4 v5, s[10:11] nt
    s_add_u32 m0, m0, 0x400
    s_nop 0
    global_load_lds_dwordx4 v6, s[10:11] nt
    v_and_b32 v5, 7, v1
    v_lshlrev_b32 v5, 1, v5
    v_xor_b32 v5, v5, v2
    v_lshlrev_b32 v5, 4, v5
    v_lshl_add_u32 v5, v1, 8, v5
    v_add_u32 v24, 131072, v5
    v_xor_b32 v25, 64, v24
    v_xor_b32 v26, 0x80, v24
    v_xor_b32 v27, 0xc0, v24
    s_lshl_b32 s42, s33, 12
    s_add_u32 s42, s42, 4096
    v_add_u32 v8, s42, v3
    s_lshl_b32 s43, s32, 9
    v_add_u32 v6, s43, v3
    s_movk_i32 s43, 0xfff
    v_and_b32 v16, s43, v6
    v_add_u32 v6, 0x400, v6
    v_and_b32 v17, s43, v6
    v_add_u32 v6, 0x400, v6
    v_and_b32 v18, s43, v6
    v_add_u32 v6, 0x400, v6
    v_and_b32 v19, s43, v6
    v_add_u32 v32, s42, v16
    v_add_u32 v33, s42, v17
    v_add_u32 v34, s42, v18
    v_add_u32 v35, s42, v19
    v_add_u32 v9, 155136, v3
    v_and_b32 v10, 1, v2
    v_lshlrev_b32 v10, 1, v10
    v_lshrrev_b32 v11, 1, v2
    v_add_u32 v10, v10, v11
    v_lshl_add_u32 v10, v1, 2, v10
    v_lshlrev_b32 v10, 2, v10
    v_add_u32 v10, 153088, v10
    v_lshlrev_b32 v11, 4, v2
    v_add_u32 v11, 153088, v11
    s_lshl_b32 s42, s2, 7
    s_add_u32 s42, s42, 135168
    v_add_u32 v12, s42, v3
    v_add_u32 v37, 8, v1
    s_mov_b32 s52, 65537
    s_mov_b32 s53, 4294901758
    s_mov_b32 s58, 0x0c04000c
    s_mov_b32 s59, 0x0402010c
    s_mov_b32 s60, 0x07060302
    s_mov_b32 s55, 0x10000
    s_waitcnt lgkmcnt(0)
    s_add_u32 s41, s41, 1
    s_addc_u32 s41, s41, 0
    v_mov_b32 v22, s41
    s_mul_i32 s54, s41, 1013904226
    s_add_u32 s54, s54, 2654435761
    s_setprio 1
    v_mov_b32 v195, v22
    v_mov_b32 v192, 0
    v_mov_b32 v193, 0
    v_mov_b32 v194, 0
    s_waitcnt vmcnt(4)
    s_mov_b32 exec_lo, 0
    global_load_dwordx4 v[192:195], v32, s[30:31] sc1
    s_mov_b32 exec_lo, -1
    global_load_dwordx4 v[196:199], v33, s[30:31] sc1
    global_load_dwordx4 v[200:203], v34, s[30:31] sc1
    global_load_dwordx4 v[204:207], v35, s[30:31] sc1
    s_waitcnt vmcnt(4)
    ds_read_b128 v[128:131], v24 offset:0
    ds_read_b128 v[132:135], v25 offset:0
    ds_read_b128 v[136:139], v26 offset:0
    ds_read_b128 v[140:143], v27 offset:0
    ds_read_b128 v[144:147], v24 offset:4096
    ds_read_b128 v[148:151], v25 offset:4096
    ds_read_b128 v[152:155], v26 offset:4096
    ds_read_b128 v[156:159], v27 offset:4096
    ds_read_b128 v[160:163], v24 offset:8192
    ds_read_b128 v[164:167], v25 offset:8192
    ds_read_b128 v[168:171], v26 offset:8192
    ds_read_b128 v[172:175], v27 offset:8192
    ds_read_b128 v[176:179], v24 offset:12288
    ds_read_b128 v[180:183], v25 offset:12288
    ds_read_b128 v[184:187], v26 offset:12288
    ds_read_b128 v[188:191], v27 offset:12288
    v_mov_b32 v44, 0
    v_mov_b32 v45, 0
    v_mov_b32 v46, 0
    v_mov_b32 v47, 0
L_fw_1:
    ds_read_b32 v15, v13 offset:0
    s_sub_u32 s34, s34, 1
    s_waitcnt lgkmcnt(0)
    v_cmp_gt_u32 vcc, 1, v15
    s_cbranch_scc1 L_fwd_2
    s_cbranch_vccnz L_fw_1
L_fwd_2:
    s_max_i32 s34, s34, 0
    s_mov_b32 exec_hi, 0
    ds_read_b128 v[44:47], v9
    s_mov_b64 exec, -1
    s_mov_b32 s46, 100000
    s_waitcnt lgkmcnt(0)
L_F1_poll:
    s_sub_u32 s46, s46, 1
    s_waitcnt vmcnt(0)
    v_xor_b32 v16, v195, v22
    v_bitop3_b32 v16, v199, v22, v16 bitop3:0xbe
    v_bitop3_b32 v16, v203, v22, v16 bitop3:0xbe
    v_bitop3_b32 v16, v207, v22, v16 bitop3:0xbe
    v_cmp_ne_u32 vcc, 0, v16
    s_cbranch_scc1 L_F1_go0
    s_cbranch_vccz L_F1_go0
    s_mov_b32 exec_lo, 0
    global_load_dwordx4 v[192:195], v32, s[30:31] sc1
    s_mov_b32 exec_lo, -1
    global_load_dwordx4 v[196:199], v33, s[30:31] sc1
    global_load_dwordx4 v[200:203], v34, s[30:31] sc1
    global_load_dwordx4 v[204:207], v35, s[30:31] sc1
    s_branch L_F1_poll
L_F1_go0:
    v_perm_b32 v195, v193, v192, s58
    v_perm_b32 v199, v197, v196, s58
    v_perm_b32 v203, v201, v200, s58
    v_perm_b32 v207, v205, v204, s58
    v_perm_b32 v195, v194, v195, s59
    v_perm_b32 v199, v198, v199, s59
    v_perm_b32 v203, v202, v203, s59
    v_perm_b32 v207, v206, v207, s59
    v_pk_add_f32 v[44:45], v[44:45], v[192:193]
    v_pk_add_f32 v[196:197], v[196:197], v[200:201]
    v_pk_add_f32 v[46:47], v[46:47], v[194:195]
    v_pk_add_f32 v[198:199], v[198:199], v[202:203]
    v_pk_add_f32 v[44:45], v[44:45], v[204:205]
    v_pk_add_f32 v[46:47], v[46:47], v[206:207]
    v_pk_add_f32 v[40:41], v[44:45], v[196:197]
    v_pk_add_f32 v[42:43], v[46:47], v[198:199]
L_F1_go:
    s_nop 1
    v_permlane32_swap_b32 v40, v42
    v_permlane32_swap_b32 v41, v43
    v_add_f32 v40, v40, v42
    v_add_f32 v41, v41, v43
    v_cvt_pk_bf16_f32 v16, v40, v41
    ds_write_b32 v10, v16
    ds_read_b128 v[96:99], v11 offset:0
    ds_read_b128 v[100:103], v11 offset:64
    ds_read_b128 v[104:107], v11 offset:128
    ds_read_b128 v[108:111], v11 offset:192
    s_waitcnt lgkmcnt(3)
    v_mfma_f32_16x16x32_bf16 v[112:115], v[96:99], v[128:131], 0
    v_mfma_f32_16x16x32_bf16 v[116:119], v[96:99], v[144:147], 0
    s_waitcnt lgkmcnt(2)
    v_mfma_f32_16x16x32_bf16 v[112:115], v[100:103], v[132:135], v[112:115]
    v_mfma_f32_16x16x32_bf16 v[116:119], v[100:103], v[148:151], v[116:119]
    s_waitcnt lgkmcnt(1)
    v_mfma_f32_16x16x32_bf16 v[112:115], v[104:107], v[136:139], v[112:115]
    v_mfma_f32_16x16x32_bf16 v[116:119], v[104:107], v[152:155], v[116:119]
    s_waitcnt lgkmcnt(0)
    v_mfma_f32_16x16x32_bf16 v[112:115], v[108:111], v[140:143], v[112:115]
    v_mfma_f32_16x16x32_bf16 v[116:119], v[108:111], v[156:159], v[116:119]
    v_mfma_f32_16x16x32_bf16 v[120:123], v[96:99], v[160:163], 0
    v_mfma_f32_16x16x32_bf16 v[124:127], v[96:99], v[176:179], 0
    v_mfma_f32_16x16x32_bf16 v[120:123], v[100:103], v[164:167], v[120:123]
    v_mfma_f32_16x16x32_bf16 v[124:127], v[100:103], v[180:183], v[124:127]
    v_mfma_f32_16x16x32_bf16 v[120:123], v[104:107], v[168:171], v[120:123]
    v_mfma_f32_16x16x32_bf16 v[124:127], v[104:107], v[184:187], v[124:127]
    v_mfma_f32_16x16x32_bf16 v[120:123], v[108:111], v[172:175], v[120:123]
    v_mfma_f32_16x16x32_bf16 v[124:127], v[108:111], v[188:191], v[124:127]
    v_cvt_pk_bf16_f32 v24, v112, v116
    v_add_u32 v112, s55, v112
    v_add_u32 v116, s55, v116
    v_perm_b32 v20, v116, v112, s60
    v_and_b32 v20, s53, v20
    v_mov_b32 v22, v24 row_ror:8
    s_nop 1
    v_cvt_pk_bf16_f32 v25, v120, v124
    v_add_u32 v120, s55, v120
    v_add_u32 v124, s55, v124
    v_perm_b32 v21, v124, v120, s60
    v_and_b32 v21, s53, v21
    v_add_u32 v16, v20, v21
    v_mov_b32 v23, v25 row_ror:8
    s_nop 0
    v_add_u32 v16, v16, v16 quad_perm:[1,0,3,2]
    s_nop 1
    v_add_u32 v16, v16, v16 quad_perm:[2,3,0,1]
    s_nop 1
    v_add_u32 v16, v16, v16 row_half_mirror
    v_sub_u32 v16, s54, v16
    v_lshrrev_b32 v17, v1, v16
    v_lshrrev_b32 v16, v37, v16
    v_and_or_b32 v20, v17, s52, v20
    v_and_or_b32 v21, v16, s52, v21
    s_mov_b64 exec, 0xff
    global_store_dwordx4 v12, v[20:23], s[30:31] sc1
    s_setprio 0
    s_mov_b64 exec, 1
    ds_add_u32 v13, v14 offset:8
    s_mov_b64 exec, -1
    s_waitcnt vmcnt(0)
    s_mov_b64 exec, 1
    ds_add_u32 v13, v14 offset:8
    s_mov_b64 exec, -1
L_PV1:
    v_lshrrev_b32 v4, 2, v0
    v_lshlrev_b32 v4, 8, v4
    v_and_b32 v5, 31, v0
    v_lshl_add_u32 v4, v5, 3, v4
    s_lshl_b32 s42, s47, 15
    v_add_u32 v4, s42, v4
    s_sub_u32 s42, s47, 0
    s_and_b32 s42, s42, 3
    s_lshl_b32 s42, s42, 10
    s_add_u32 s42, s42, 147456
    v_add_u32 v48, s42, v3
    s_sub_u32 s42, s47, 1
    s_and_b32 s42, s42, 3
    s_lshl_b32 s42, s42, 10
    s_add_u32 s42, s42, 147456
    v_add_u32 v49, s42, v3
    s_sub_u32 s42, s47, 2
    s_and_b32 s42, s42, 3
    s_lshl_b32 s42, s42, 10
    s_add_u32 s42, s42, 147456
    v_add_u32 v50, s42, v3
    s_sub_u32 s42, s47, 3
    s_and_b32 s42, s42, 3
    s_lshl_b32 s42, s42, 10
    s_add_u32 s42, s42, 147456
    v_add_u32 v51, s42, v3
    s_lshl_b32 s42, s35, 6
    s_add_u32 s42, s42, s47
    s_lshl_b32 s42, s42, 7
    s_add_u32 s42, s42, s36
    s_lshl_b32 s43, s42, 8
    s_add_u32 s43, s43, 2097152
    v_lshlrev_b32 v52, 19, v2
    v_lshl_add_u32 v52, v1, 4, v52
    v_add_u32 v52, s43, v52
    s_mov_b32 s44, 0x20000
    v_add_u32 v53, s44, v52
    v_add_u32 v54, s44, v53
    v_add_u32 v55, s44, v54
    v_lshlrev_b32 v42, 4, v2
    v_lshl_add_u32 v43, v1, 6, v42
    v_add_u32 v43, 157696, v43
    v_add_u32 v42, 152832, v42
    s_mul_i32 s58, s41, 1013904226
    s_add_u32 s58, s58, 2654435761
    s_mov_b32 s59, 65537
    s_mov_b32 s60, 4294901758
    v_mov_b32 v28, 0
    v_mov_b32 v29, 0
    v_mov_b32 v30, 0
    v_mov_b32 v31, 0
    global_store_dwordx4 v52, v[28:31], s[30:31] sc1
    global_store_dwordx4 v53, v[28:31], s[30:31] sc1
    global_store_dwordx4 v54, v[28:31], s[30:31] sc1
    global_store_dwordx4 v55, v[28:31], s[30:31] sc1
    s_sub_u32 s42, s47, 0
    s_and_b32 s42, s42, 3
    s_lshl_b32 s43, s42, 13
    v_lshl_add_u32 v5, s42, 2, v13
    v_add_u32 v16, s43, v4
    v_xor_b32 v17, 32, v16
    v_xor_b32 v18, 64, v16
    v_xor_b32 v19, 96, v16
    v_xor_b32 v20, 128, v16
    v_xor_b32 v21, 160, v16
    v_xor_b32 v22, 192, v16
    v_xor_b32 v23, 224, v16
L_fw_3:
    ds_read_b32 v15, v5 offset:32
    s_sub_u32 s34, s34, 1
    s_waitcnt lgkmcnt(0)
    v_cmp_gt_u32 vcc, 1, v15
    s_cbranch_scc1 L_fwd_4
    s_cbranch_vccnz L_fw_3
L_fwd_4:
    s_max_i32 s34, s34, 0
    ds_read_b64_tr_b16 v[128:129], v16 offset:0
    ds_read_b64_tr_b16 v[130:131], v16 offset:4096
    ds_read_b64_tr_b16 v[132:133], v17 offset:0
    ds_read_b64_tr_b16 v[134:135], v17 offset:4096
    ds_read_b64_tr_b16 v[136:137], v18 offset:0
    ds_read_b64_tr_b16 v[138:139], v18 offset:4096
    ds_read_b64_tr_b16 v[140:141], v19 offset:0
    ds_read_b64_tr_b16 v[142:143], v19 offset:4096
    ds_read_b64_tr_b16 v[144:145], v20 offset:0
    ds_read_b64_tr_b16 v[146:147], v20 offset:4096
    ds_read_b64_tr_b16 v[148:149], v21 offset:0
    ds_read_b64_tr_b16 v[150:151], v21 offset:4096
    ds_read_b64_tr_b16 v[152:153], v22 offset:0
    ds_read_b64_tr_b16 v[154:155], v22 offset:4096
    ds_read_b64_tr_b16 v[156:157], v23 offset:0
    ds_read_b64_tr_b16 v[158:159], v23 offset:4096
    s_sub_u32 s42, s47, 1
    s_and_b32 s42, s42, 3
    s_lshl_b32 s43, s42, 13
    v_lshl_add_u32 v5, s42, 2, v13
    v_add_u32 v16, s43, v4
    v_xor_b32 v17, 32, v16
    v_xor_b32 v18, 64, v16
    v_xor_b32 v19, 96, v16
    v_xor_b32 v20, 128, v16
    v_xor_b32 v21, 160, v16
    v_xor_b32 v22, 192, v16
    v_xor_b32 v23, 224, v16
L_fw_5:
    ds_read_b32 v15, v5 offset:32
    s_sub_u32 s34, s34, 1
    s_waitcnt lgkmcnt(0)
    v_cmp_gt_u32 vcc, 2, v15
    s_cbranch_scc1 L_fwd_6
    s_cbranch_vccnz L_fw_5
L_fwd_6:
    s_max_i32 s34, s34, 0
    ds_read_b64_tr_b16 v[160:161], v16 offset:0
    ds_read_b64_tr_b16 v[162:163], v16 offset:4096
    ds_read_b64_tr_b16 v[164:165], v17 offset:0
    ds_read_b64_tr_b16 v[166:167], v17 offset:4096
    ds_read_b64_tr_b16 v[168:169], v18 offset:0
    ds_read_b64_tr_b16 v[170:171], v18 offset:4096
    ds_read_b64_tr_b16 v[172:173], v19 offset:0
    ds_read_b64_tr_b16 v[174:175], v19 offset:4096
    ds_read_b64_tr_b16 v[176:177], v20 offset:0
    ds_read_b64_tr_b16 v[178:179], v20 offset:4096
    ds_read_b64_tr_b16 v[180:181], v21 offset:0
    ds_read_b64_tr_b16 v[182:183], v21 offset:4096
    ds_read_b64_tr_b16 v[184:185], v22 offset:0
    ds_read_b64_tr_b16 v[186:187], v22 offset:4096
    ds_read_b64_tr_b16 v[188:189], v23 offset:0
    ds_read_b64_tr_b16 v[190:191], v23 offset:4096
    s_branch L_PVs
L_F23:
    s_load_dwordx8 s[20:27], s[0:1], 64
    v_and_b32 v0, 63, v0
    v_and_b32 v1, 15, v0
    v_lshrrev_b32 v2, 4, v0
    v_lshlrev_b32 v3, 4, v0
    s_and_b32 s32, s2, 7
    s_lshr_b32 s33, s2, 3
    s_lshr_b32 s3, s3, 1
    s_lshr_b32 s35, s33, 4
    s_xor_b32 s35, s35, 1
    s_and_b32 s42, s33, 15
    s_lshl4_add_u32 s36, s32, s42
    s_and_b32 s47, s3, 3
    v_mov_b32 v13, 158720
    v_mov_b32 v14, 1
    s_mov_b32 s34, 0x1000000
    s_cmp_eq_u32 s3, 2
    s_cbranch_scc0 L_F3
    v_mov_b32 v16, 0
    v_mov_b32 v17, 0
    v_mov_b32 v18, 0
    v_mov_b32 v19, 0
    v_and_b32 v20, 3, v0
    v_lshl_add_u32 v20, v20, 4, v13
    ds_write_b128 v20, v[16:19]
    v_lshlrev_b32 v20, 2, v1
    v_add_u32 v20, 152960, v20
    v_mov_b32 v21, 0xff800000
    ds_write_b32 v20, v21
L_F3:
    s_waitcnt lgkmcnt(0)
    s_load_dword s41, s[30:31], 0
    s_waitcnt lgkmcnt(0)
    s_barrier
    s_waitcnt lgkmcnt(0)
    s_add_u32 s41, s41, 1
    s_addc_u32 s41, s41, 0
    s_cmp_eq_u32 s3, 2
    s_cbranch_scc1 L_F2
    s_cmp_ge_u32 s2, 224
    s_cbranch_scc1 L_PV1
    s_lshr_b32 s42, s2, 4
    s_lshl_b32 s42, s42, 8
    s_and_b32 s43, s2, 15
    s_add_u32 s42, s42, s43
    s_lshl_b32 s42, s42, 7
    s_add_u32 s42, s42, 200704
    v_lshrrev_b32 v16, 3, v0
    v_lshlrev_b32 v16, 11, v16
    v_and_b32 v17, 7, v0
    v_lshl_add_u32 v16, v17, 4, v16
    v_add_u32 v16, s42, v16
    v_add_u32 v17, 0x4000, v16
    v_mov_b32 v20, 0
    v_mov_b32 v21, 0
    v_mov_b32 v22, 0
    v_mov_b32 v23, 0
    global_store_dwordx4 v16, v[20:23], s[30:31] sc1
    global_store_dwordx4 v17, v[20:23], s[30:31] sc1
L_fw_7:
    ds_read_b32 v15, v13 offset:0
    s_sub_u32 s34, s34, 1
    s_waitcnt lgkmcnt(0)
    v_cmp_gt_u32 vcc, 1, v15
    s_cbranch_scc1 L_fwd_8
    s_cbranch_vccnz L_fw_7
L_fwd_8:
    s_max_i32 s34, s34, 0
    s_and_b32 s45, s2, 15
    s_mul_i32 s42, s45, 114688
    s_lshr_b32 s43, s2, 4
    s_lshl_b32 s43, s43, 8
    s_add_u32 s42, s42, s43
    v_mul_u32_u24 v12, 28672, v2
    v_lshl_add_u32 v12, v1, 4, v12
    v_add_u32 v12, s42, v12
    s_movk_i32 s44, 7168
    global_load_dwordx4 v[56:59], v12, s[18:19] offset:0 nt
    global_load_dwordx4 v[60:63], v12, s[18:19] offset:3584 nt
    v_add_u32 v12, s44, v12
    global_load_dwordx4 v[64:67], v12, s[18:19] offset:0 nt
    global_load_dwordx4 v[68:71], v12, s[18:19] offset:3584 nt
    v_add_u32 v12, s44, v12
    global_load_dwordx4 v[72:75], v12, s[18:19] offset:0 nt
    global_load_dwordx4 v[76:79], v12, s[18:19] offset:3584 nt
    v_add_u32 v12, s44, v12
    global_load_dwordx4 v[8:11], v12, s[18:19] offset:0 nt
    global_load_dwordx4 v[4:7], v12, s[18:19] offset:3584 nt
    s_and_b32 s45, s2, 15
    s_lshr_b32 s43, s2, 4
    s_lshl_b32 s43, s43, 8
    s_lshl_b32 s45, s45, 6
    s_add_u32 s42, s45, 151552
    v_lshl_add_u32 v144, v2, 4, s42
    ds_read_b128 v[80:83], v144
    s_lshl_b32 s42, s43, 6
    s_add_u32 s42, s42, s45
    s_lshl_b32 s42, s42, 1
    s_add_u32 s42, s42, 200704
    v_lshrrev_b32 v145, 2, v0
    v_lshlrev_b32 v146, 11, v145
    v_and_b32 v147, 3, v0
    v_lshl_add_u32 v146, v147, 4, v146
    v_add_u32 v146, s42, v146
    v_cmp_gt_u32 s[50:51], v0, 31
    s_and_b32 s42, s2, 3
    s_lshl_b32 s42, s42, 6
    s_add_u32 s42, s42, s43
    s_bfe_u32 s43, s2, 0x10002
    s_lshl3_add_u32 s42, s43, s42
    s_bfe_u32 s43, s2, 0x10003
    s_lshl2_add_u32 s42, s43, s42
    v_lshl_add_u32 v148, v147, 4, s42
    s_lshl_b32 s42, s2, 11
    s_add_u32 s42, s42, 200704
    v_lshlrev_b32 v147, 4, v147
    v_lshl_add_u32 v147, v145, 7, v147
    v_add_u32 v147, s42, v147
    v_lshlrev_b32 v149, 3, v0
    v_add_u32 v149, 157184, v149
    s_mov_b32 s45, 0xffff0000
    v_and_b32 v150, 1, v1
    v_cmp_eq_u32 vcc, 1, v150
    v_mov_b32 v151, 0x0c0c0100
    v_mov_b32 v152, 0x01000c0c
    v_cndmask_b32 v151, v151, v152, vcc
    v_mov_b32 v152, 0x0c0c0302
    v_mov_b32 v153, 0x03020c0c
    v_cndmask_b32 v152, v152, v153, vcc
    v_mov_b32 v153, 0x0c0c0c0c
    v_bfe_u32 v150, v1, 1, 2
    v_cmp_eq_u32 vcc, 0, v150
    s_nop 1
    v_cndmask_b32 v136, v153, v151, vcc
    v_cndmask_b32 v140, v153, v152, vcc
    v_cmp_eq_u32 vcc, 1, v150
    s_nop 1
    v_cndmask_b32 v137, v153, v151, vcc
    v_cndmask_b32 v141, v153, v152, vcc
    v_cmp_eq_u32 vcc, 2, v150
    s_nop 1
    v_cndmask_b32 v138, v153, v151, vcc
    v_cndmask_b32 v142, v153, v152, vcc
    v_cmp_eq_u32 vcc, 3, v150
    s_nop 1
    v_cndmask_b32 v139, v153, v151, vcc
    v_cndmask_b32 v143, v153, v152, vcc
    s_waitcnt lgkmcnt(0)
    v_perm_b32 v128, v80, v80, v136
    v_perm_b32 v129, v80, v80, v137
    v_perm_b32 v130, v80, v80, v138
    v_perm_b32 v131, v80, v80, v139
    v_perm_b32 v132, v80, v80, v140
    v_perm_b32 v133, v80, v80, v141
    v_perm_b32 v134, v80, v80, v142
    v_perm_b32 v135, v80, v80, v143
    s_waitcnt vmcnt(7)
    v_mfma_f32_16x16x32_bf16 v[88:91], v[128:131], v[56:59], 0
    v_perm_b32 v128, v81, v81, v136
    v_perm_b32 v129, v81, v81, v137
    v_perm_b32 v130, v81, v81, v138
    v_perm_b32 v131, v81, v81, v139
    s_waitcnt vmcnt(6)
    v_mfma_f32_16x16x32_bf16 v[88:91], v[132:135], v[60:63], v[88:91]
    v_perm_b32 v132, v81, v81, v140
    v_perm_b32 v133, v81, v81, v141
    v_perm_b32 v134, v81, v81, v142
    v_perm_b32 v135, v81, v81, v143
    s_waitcnt vmcnt(5)
    v_mfma_f32_16x16x32_bf16 v[88:91], v[128:131], v[64:67], v[88:91]
    v_perm_b32 v128, v82, v82, v136
    v_perm_b32 v129, v82, v82, v137
    v_perm_b32 v130, v82, v82, v138
    v_perm_b32 v131, v82, v82, v139
    s_waitcnt vmcnt(4)
    v_mfma_f32_16x16x32_bf16 v[88:91], v[132:135], v[68:71], v[88:91]
    v_perm_b32 v132, v82, v82, v140
    v_perm_b32 v133, v82, v82, v141
    v_perm_b32 v134, v82, v82, v142
    v_perm_b32 v135, v82, v82, v143
    s_waitcnt vmcnt(3)
    v_mfma_f32_16x16x32_bf16 v[88:91], v[128:131], v[72:75], v[88:91]
    v_perm_b32 v128, v83, v83, v136
    v_perm_b32 v129, v83, v83, v137
    v_perm_b32 v130, v83, v83, v138
    v_perm_b32 v131, v83, v83, v139
    s_waitcnt vmcnt(2)
    v_mfma_f32_16x16x32_bf16 v[88:91], v[132:135], v[76:79], v[88:91]
    v_perm_b32 v132, v83, v83, v140
    v_perm_b32 v133, v83, v83, v141
    v_perm_b32 v134, v83, v83, v142
    v_perm_b32 v135, v83, v83, v143
    s_waitcnt vmcnt(1)
    v_mfma_f32_16x16x32_bf16 v[88:91], v[128:131], v[8:11], v[88:91]
    v_mov_b32 v94, s41
    v_mov_b32 v95, s41
    s_waitcnt vmcnt(0)
    v_mfma_f32_16x16x32_bf16 v[88:91], v[132:135], v[4:7], v[88:91]
    s_nop 7
    v_cndmask_b32 v92, v88, v90, s[50:51]
    v_cndmask_b32 v93, v89, v91, s[50:51]
    global_store_dwordx4 v146, v[92:95], s[30:31] sc1
    global_load_dword v28, v148, s[20:21]
    s_mov_b32 s46, 100000
L_fw_9:
    ds_read_b32 v15, v13 offset:4
    s_sub_u32 s34, s34, 1
    s_waitcnt lgkmcnt(0)
    v_cmp_gt_u32 vcc, 4, v15
    s_cbranch_scc1 L_fwd_10
    s_cbranch_vccnz L_fw_9
L_fwd_10:
    s_max_i32 s34, s34, 0
L_TF:
    global_load_dwordx4 v[24:27], v147, s[30:31] sc1
    s_sub_u32 s46, s46, 1
    s_waitcnt vmcnt(0)
    v_cmp_ne_u32 vcc, v26, v94
    s_cbranch_scc1 L_TF_go
    s_cbranch_vccnz L_TF
L_TF_go:
    v_add_f32 v24, v24, v24 row_ror:4
    v_add_f32 v25, v25, v25 row_ror:4
    s_nop 0
    v_add_f32 v24, v24, v24 row_ror:8
    v_add_f32 v25, v25, v25 row_ror:8
    s_nop 1
    v_permlane32_swap_b32 v24, v25
    v_add_f32 v24, v24, v25
    v_mov_b32 v25, v24
    s_nop 1
    v_permlane16_swap_b32 v24, v25
    v_lshlrev_b32 v16, 16, v28
    v_add_f32 v24, v24, v25
    v_and_b32 v17, s45, v28
    v_cvt_pk_bf16_f32 v24, v24, v24
    v_cndmask_b32 v16, v16, v17, s[50:51]
    v_and_b32 v24, s45, v24
    v_add_f32 v24, v24, v16
    v_cvt_pk_bf16_f32 v24, v24, v24
    v_and_b32 v24, s45, v24
    v_max_f32 v24, 0, v24
    v_mul_f32 v24, v24, v24
    v_cvt_pk_bf16_f32 v24, v24, v24
    v_mov_b32 v25, v24
    s_nop 1
    v_permlane32_swap_b32 v24, v25
    s_nop 1
    v_mov_b32 v26, v24 row_newbcast:0 row_mask:1
    v_mov_b32 v27, v25 row_newbcast:0 row_mask:1
    s_nop 0
    v_mov_b32 v26, v24 row_newbcast:1 row_mask:2
    v_mov_b32 v27, v25 row_newbcast:1 row_mask:2
    s_nop 0
    v_mov_b32 v26, v24 row_newbcast:2 row_mask:4
    v_mov_b32 v27, v25 row_newbcast:2 row_mask:4
    s_nop 0
    v_mov_b32 v26, v24 row_newbcast:3 row_mask:8
    v_mov_b32 v27, v25 row_newbcast:3 row_mask:8
    ds_write_b64 v149, v[26:27]
    s_branch L_PV1
L_F2:
L_fw_11:
    ds_read_b32 v15, v13 offset:0
    s_sub_u32 s34, s34, 1
    s_waitcnt lgkmcnt(0)
    v_cmp_gt_u32 vcc, 1, v15
    s_cbranch_scc1 L_fwd_12
    s_cbranch_vccnz L_fw_11
L_fwd_12:
    s_max_i32 s34, s34, 0
    s_mov_b64 exec, 0
    s_branch L_PVC
L_PVC_back:
    s_mov_b64 exec, -1
L_QG:
    s_lshr_b32 s43, s3, 1
    s_lshl1_add_u32 s42, s35, s43
    s_lshl_b32 s42, s42, 13
    s_add_u32 s42, s42, 135168
    v_add_u32 v8, s42, v3
    v_add_u32 v9, 0x1000, v8
    v_and_b32 v10, 7, v0
    v_add_u32 v11, 8, v10
    v_lshlrev_b32 v6, 4, v10
    v_lshl_add_u32 v6, v0, 8, v6
    s_lshl_b32 s43, s43, 7
    s_add_u32 s43, s43, 131072
    v_add_u32 v56, s43, v6
    s_mul_i32 s54, s41, 3816266512
    s_add_u32 s54, s54, 4055616904
    v_xor_b32 v57, 16, v56
    v_xor_b32 v58, 32, v56
    v_xor_b32 v59, 48, v56
    v_xor_b32 v60, 64, v56
    v_xor_b32 v61, 80, v56
    v_xor_b32 v62, 96, v56
    v_xor_b32 v63, 112, v56
    v_lshrrev_b32 v4, 2, v0
    v_lshlrev_b32 v4, 8, v4
    v_and_b32 v5, 31, v0
    v_lshl_add_u32 v4, v5, 3, v4
    s_lshl_b32 s42, s47, 15
    v_add_u32 v4, s42, v4
    s_sub_u32 s42, s47, 0
    s_and_b32 s42, s42, 3
    s_lshl_b32 s42, s42, 10
    s_add_u32 s42, s42, 147456
    v_add_u32 v48, s42, v3
    s_sub_u32 s42, s47, 1
    s_and_b32 s42, s42, 3
    s_lshl_b32 s42, s42, 10
    s_add_u32 s42, s42, 147456
    v_add_u32 v49, s42, v3
    s_sub_u32 s42, s47, 2
    s_and_b32 s42, s42, 3
    s_lshl_b32 s42, s42, 10
    s_add_u32 s42, s42, 147456
    v_add_u32 v50, s42, v3
    s_sub_u32 s42, s47, 3
    s_and_b32 s42, s42, 3
    s_lshl_b32 s42, s42, 10
    s_add_u32 s42, s42, 147456
    v_add_u32 v51, s42, v3
    s_lshl_b32 s42, s35, 6
    s_add_u32 s42, s42, s47
    s_lshl_b32 s42, s42, 7
    s_add_u32 s42, s42, s36
    s_lshl_b32 s43, s42, 8
    s_add_u32 s43, s43, 2097152
    v_lshlrev_b32 v52, 19, v2
    v_lshl_add_u32 v52, v1, 4, v52
    v_add_u32 v52, s43, v52
    s_mov_b32 s44, 0x20000
    v_add_u32 v53, s44, v52
    v_add_u32 v54, s44, v53
    v_add_u32 v55, s44, v54
    v_lshlrev_b32 v42, 4, v2
    v_lshl_add_u32 v43, v1, 6, v42
    v_add_u32 v43, 157696, v43
    v_add_u32 v42, 152832, v42
    s_mul_i32 s58, s41, 1013904226
    s_add_u32 s58, s58, 2654435761
    s_mov_b32 s59, 65537
    s_mov_b32 s60, 4294901758
    v_mov_b32 v28, 0
    v_mov_b32 v29, 0
    v_mov_b32 v30, 0
    v_mov_b32 v31, 0
    global_store_dwordx4 v52, v[28:31], s[30:31] sc1
    global_store_dwordx4 v53, v[28:31], s[30:31] sc1
    global_store_dwordx4 v54, v[28:31], s[30:31] sc1
    global_store_dwordx4 v55, v[28:31], s[30:31] sc1
    s_setprio 1
L_fw_13:
    ds_read_b32 v15, v13 offset:4
    s_sub_u32 s34, s34, 1
    s_waitcnt lgkmcnt(0)
    v_cmp_gt_u32 vcc, 4, v15
    s_cbranch_scc1 L_fwd_14
    s_cbranch_vccnz L_fw_13
L_fwd_14:
    s_max_i32 s34, s34, 0
L_fw_15:
    ds_read_b32 v15, v13 offset:8
    s_sub_u32 s34, s34, 1
    s_waitcnt lgkmcnt(0)
    v_cmp_gt_u32 vcc, 2, v15
    s_cbranch_scc1 L_fwd_16
    s_cbranch_vccnz L_fw_15
L_fwd_16:
    s_max_i32 s34, s34, 0
    global_load_dwordx4 v[64:67], v8, s[30:31] offset:0 sc1
    global_load_dwordx4 v[68:71], v8, s[30:31] offset:1024 sc1
    global_load_dwordx4 v[72:75], v8, s[30:31] offset:2048 sc1
    global_load_dwordx4 v[76:79], v8, s[30:31] offset:3072 sc1
    global_load_dwordx4 v[80:83], v9, s[30:31] offset:0 sc1
    global_load_dwordx4 v[84:87], v9, s[30:31] offset:1024 sc1
    global_load_dwordx4 v[88:91], v9, s[30:31] offset:2048 sc1
    global_load_dwordx4 v[92:95], v9, s[30:31] offset:3072 sc1
    s_sub_u32 s42, s47, 0
    s_and_b32 s42, s42, 3
    s_lshl_b32 s43, s42, 13
    v_lshl_add_u32 v5, s42, 2, v13
    v_add_u32 v16, s43, v4
    v_xor_b32 v17, 32, v16
    v_xor_b32 v18, 64, v16
    v_xor_b32 v19, 96, v16
    v_xor_b32 v20, 128, v16
    v_xor_b32 v21, 160, v16
    v_xor_b32 v22, 192, v16
    v_xor_b32 v23, 224, v16
L_fw_17:
    ds_read_b32 v15, v5 offset:32
    s_sub_u32 s34, s34, 1
    s_waitcnt lgkmcnt(0)
    v_cmp_gt_u32 vcc, 1, v15
    s_cbranch_scc1 L_fwd_18
    s_cbranch_vccnz L_fw_17
L_fwd_18:
    s_max_i32 s34, s34, 0
    ds_read_b64_tr_b16 v[128:129], v16 offset:0
    ds_read_b64_tr_b16 v[130:131], v16 offset:4096
    ds_read_b64_tr_b16 v[132:133], v17 offset:0
    ds_read_b64_tr_b16 v[134:135], v17 offset:4096
    ds_read_b64_tr_b16 v[136:137], v18 offset:0
    ds_read_b64_tr_b16 v[138:139], v18 offset:4096
    ds_read_b64_tr_b16 v[140:141], v19 offset:0
    ds_read_b64_tr_b16 v[142:143], v19 offset:4096
    ds_read_b64_tr_b16 v[144:145], v20 offset:0
    ds_read_b64_tr_b16 v[146:147], v20 offset:4096
    ds_read_b64_tr_b16 v[148:149], v21 offset:0
    ds_read_b64_tr_b16 v[150:151], v21 offset:4096
    ds_read_b64_tr_b16 v[152:153], v22 offset:0
    ds_read_b64_tr_b16 v[154:155], v22 offset:4096
    ds_read_b64_tr_b16 v[156:157], v23 offset:0
    ds_read_b64_tr_b16 v[158:159], v23 offset:4096
    s_sub_u32 s42, s47, 1
    s_and_b32 s42, s42, 3
    s_lshl_b32 s43, s42, 13
    v_lshl_add_u32 v5, s42, 2, v13
    v_add_u32 v16, s43, v4
    v_xor_b32 v17, 32, v16
    v_xor_b32 v18, 64, v16
    v_xor_b32 v19, 96, v16
    v_xor_b32 v20, 128, v16
    v_xor_b32 v21, 160, v16
    v_xor_b32 v22, 192, v16
    v_xor_b32 v23, 224, v16
L_fw_19:
    ds_read_b32 v15, v5 offset:32
    s_sub_u32 s34, s34, 1
    s_waitcnt lgkmcnt(0)
    v_cmp_gt_u32 vcc, 2, v15
    s_cbranch_scc1 L_fwd_20
    s_cbranch_vccnz L_fw_19
L_fwd_20:
    s_max_i32 s34, s34, 0
    ds_read_b64_tr_b16 v[160:161], v16 offset:0
    ds_read_b64_tr_b16 v[162:163], v16 offset:4096
    ds_read_b64_tr_b16 v[164:165], v17 offset:0
    ds_read_b64_tr_b16 v[166:167], v17 offset:4096
    ds_read_b64_tr_b16 v[168:169], v18 offset:0
    ds_read_b64_tr_b16 v[170:171], v18 offset:4096
    ds_read_b64_tr_b16 v[172:173], v19 offset:0
    ds_read_b64_tr_b16 v[174:175], v19 offset:4096
    ds_read_b64_tr_b16 v[176:177], v20 offset:0
    ds_read_b64_tr_b16 v[178:179], v20 offset:4096
    ds_read_b64_tr_b16 v[180:181], v21 offset:0
    ds_read_b64_tr_b16 v[182:183], v21 offset:4096
    ds_read_b64_tr_b16 v[184:185], v22 offset:0
    ds_read_b64_tr_b16 v[186:187], v22 offset:4096
    ds_read_b64_tr_b16 v[188:189], v23 offset:0
    ds_read_b64_tr_b16 v[190:191], v23 offset:4096
    s_mov_b32 s46, 100000
L_QG_chk:
    s_waitcnt vmcnt(7)
    v_and_b32 v6, s59, v64
    v_and_b32 v7, s59, v65
    v_xor_b32 v64, v6, v64
    v_xor_b32 v65, v7, v65
    ds_write_b128 v56, v[64:67]
    v_lshl_add_u32 v24, v6, v10, 0
    v_lshl_add_u32 v24, v7, v11, v24
    v_add3_u32 v24, v64, v65, v24
    s_waitcnt vmcnt(6)
    v_and_b32 v6, s59, v68
    v_and_b32 v7, s59, v69
    v_xor_b32 v68, v6, v68
    v_xor_b32 v69, v7, v69
    ds_write_b128 v57, v[68:71]
    v_lshl_add_u32 v24, v6, v10, v24
    v_lshl_add_u32 v24, v7, v11, v24
    v_add3_u32 v24, v68, v69, v24
    s_waitcnt vmcnt(5)
    v_and_b32 v6, s59, v72
    v_and_b32 v7, s59, v73
    v_xor_b32 v72, v6, v72
    v_xor_b32 v73, v7, v73
    ds_write_b128 v58, v[72:75]
    v_lshl_add_u32 v24, v6, v10, v24
    v_lshl_add_u32 v24, v7, v11, v24
    v_add3_u32 v24, v72, v73, v24
    s_waitcnt vmcnt(4)
    v_and_b32 v6, s59, v76
    v_and_b32 v7, s59, v77
    v_xor_b32 v76, v6, v76
    v_xor_b32 v77, v7, v77
    ds_write_b128 v59, v[76:79]
    v_lshl_add_u32 v24, v6, v10, v24
    v_lshl_add_u32 v24, v7, v11, v24
    v_add3_u32 v24, v76, v77, v24
    s_waitcnt vmcnt(3)
    v_and_b32 v6, s59, v80
    v_and_b32 v7, s59, v81
    v_xor_b32 v80, v6, v80
    v_xor_b32 v81, v7, v81
    ds_write_b128 v60, v[80:83]
    v_lshl_add_u32 v24, v6, v10, v24
    v_lshl_add_u32 v24, v7, v11, v24
    v_add3_u32 v24, v80, v81, v24
    s_waitcnt vmcnt(2)
    v_and_b32 v6, s59, v84
    v_and_b32 v7, s59, v85
    v_xor_b32 v84, v6, v84
    v_xor_b32 v85, v7, v85
    ds_write_b128 v61, v[84:87]
    v_lshl_add_u32 v24, v6, v10, v24
    v_lshl_add_u32 v24, v7, v11, v24
    v_add3_u32 v24, v84, v85, v24
    s_waitcnt vmcnt(1)
    v_and_b32 v6, s59, v88
    v_and_b32 v7, s59, v89
    v_xor_b32 v88, v6, v88
    v_xor_b32 v89, v7, v89
    ds_write_b128 v62, v[88:91]
    v_lshl_add_u32 v24, v6, v10, v24
    v_lshl_add_u32 v24, v7, v11, v24
    v_add3_u32 v24, v88, v89, v24
    s_waitcnt vmcnt(0)
    v_and_b32 v6, s59, v92
    v_and_b32 v7, s59, v93
    v_xor_b32 v92, v6, v92
    v_xor_b32 v93, v7, v93
    ds_write_b128 v63, v[92:95]
    v_lshl_add_u32 v24, v6, v10, v24
    v_lshl_add_u32 v24, v7, v11, v24
    v_add3_u32 v24, v92, v93, v24
    s_nop 1
    v_add_u32 v24, v24, v24 quad_perm:[1,0,3,2]
    s_nop 1
    v_add_u32 v24, v24, v24 quad_perm:[2,3,0,1]
    s_nop 1
    v_add_u32 v24, v24, v24 row_half_mirror
    s_sub_u32 s46, s46, 1
    v_cmp_ne_u32 vcc, s54, v24
    s_cbranch_scc1 L_QG_go
    s_cbranch_vccz L_QG_go
    s_waitcnt lgkmcnt(0)
    s_mov_b64 exec, vcc
    global_load_dwordx4 v[64:67], v8, s[30:31] offset:0 sc1
    global_load_dwordx4 v[68:71], v8, s[30:31] offset:1024 sc1
    global_load_dwordx4 v[72:75], v8, s[30:31] offset:2048 sc1
    global_load_dwordx4 v[76:79], v8, s[30:31] offset:3072 sc1
    global_load_dwordx4 v[80:83], v9, s[30:31] offset:0 sc1
    global_load_dwordx4 v[84:87], v9, s[30:31] offset:1024 sc1
    global_load_dwordx4 v[88:91], v9, s[30:31] offset:2048 sc1
    global_load_dwordx4 v[92:95], v9, s[30:31] offset:3072 sc1
    s_branch L_QG_chk
L_QG_go:
    s_mov_b64 exec, 1
    ds_add_u32 v13, v14 offset:12
    s_mov_b64 exec, -1
    s_setprio 0
L_PVs:
    s_sub_u32 s42, s47, 2
    s_and_b32 s42, s42, 3
    s_lshl_b32 s43, s42, 13
    v_lshl_add_u32 v5, s42, 2, v13
    v_add_u32 v16, s43, v4
    v_xor_b32 v17, 32, v16
    v_xor_b32 v18, 64, v16
    v_xor_b32 v19, 96, v16
    v_xor_b32 v20, 128, v16
    v_xor_b32 v21, 160, v16
    v_xor_b32 v22, 192, v16
    v_xor_b32 v23, 224, v16
L_fw_21:
    ds_read_b32 v15, v5 offset:32
    s_sub_u32 s34, s34, 1
    s_waitcnt lgkmcnt(0)
    v_cmp_gt_u32 vcc, 3, v15
    s_cbranch_scc1 L_fwd_22
    s_cbranch_vccnz L_fw_21
L_fwd_22:
    s_max_i32 s34, s34, 0
    ds_read_b64_tr_b16 v[192:193], v16 offset:0
    ds_read_b64_tr_b16 v[194:195], v16 offset:4096
    ds_read_b64_tr_b16 v[196:197], v17 offset:0
    ds_read_b64_tr_b16 v[198:199], v17 offset:4096
    ds_read_b64_tr_b16 v[200:201], v18 offset:0
    ds_read_b64_tr_b16 v[202:203], v18 offset:4096
    ds_read_b64_tr_b16 v[204:205], v19 offset:0
    ds_read_b64_tr_b16 v[206:207], v19 offset:4096
    ds_read_b64_tr_b16 v[208:209], v20 offset:0
    ds_read_b64_tr_b16 v[210:211], v20 offset:4096
    ds_read_b64_tr_b16 v[212:213], v21 offset:0
    ds_read_b64_tr_b16 v[214:215], v21 offset:4096
    ds_read_b64_tr_b16 v[216:217], v22 offset:0
    ds_read_b64_tr_b16 v[218:219], v22 offset:4096
    ds_read_b64_tr_b16 v[220:221], v23 offset:0
    ds_read_b64_tr_b16 v[222:223], v23 offset:4096
    s_sub_u32 s42, s47, 3
    s_and_b32 s42, s42, 3
    s_lshl_b32 s43, s42, 13
    v_lshl_add_u32 v5, s42, 2, v13
    v_add_u32 v16, s43, v4
    v_xor_b32 v17, 32, v16
    v_xor_b32 v18, 64, v16
    v_xor_b32 v19, 96, v16
    v_xor_b32 v20, 128, v16
    v_xor_b32 v21, 160, v16
    v_xor_b32 v22, 192, v16
    v_xor_b32 v23, 224, v16
    s_barrier
    ds_read_b64_tr_b16 v[224:225], v16 offset:0
    ds_read_b64_tr_b16 v[226:227], v16 offset:4096
    ds_read_b64_tr_b16 v[228:229], v17 offset:0
    ds_read_b64_tr_b16 v[230:231], v17 offset:4096
    ds_read_b64_tr_b16 v[232:233], v18 offset:0
    ds_read_b64_tr_b16 v[234:235], v18 offset:4096
    ds_read_b64_tr_b16 v[236:237], v19 offset:0
    ds_read_b64_tr_b16 v[238:239], v19 offset:4096
    ds_read_b64_tr_b16 v[240:241], v20 offset:0
    ds_read_b64_tr_b16 v[242:243], v20 offset:4096
    ds_read_b64_tr_b16 v[244:245], v21 offset:0
    ds_read_b64_tr_b16 v[246:247], v21 offset:4096
    ds_read_b64_tr_b16 v[248:249], v22 offset:0
    ds_read_b64_tr_b16 v[250:251], v22 offset:4096
    ds_read_b64_tr_b16 v[252:253], v23 offset:0
    ds_read_b64_tr_b16 v[254:255], v23 offset:4096
L_PV:
    s_setprio 3
    s_barrier
L_PVC:
    ds_read_b128 v[80:83], v48
    ds_read_b128 v[84:87], v49
    ds_read_b128 v[88:91], v50
    ds_read_b128 v[92:95], v51
    ds_read_b128 v[32:35], v43
    ds_read_b128 v[36:39], v42
    s_mov_b32 s42, 0xffff
    s_waitcnt lgkmcnt(5)
    v_mfma_f32_16x16x32_bf16 v[96:99], v[80:83], v[128:131], 0
    v_mfma_f32_16x16x32_bf16 v[100:103], v[80:83], v[132:135], 0
    s_waitcnt lgkmcnt(4)
    v_mfma_f32_16x16x32_bf16 v[96:99], v[84:87], v[160:163], v[96:99]
    s_waitcnt lgkmcnt(0)
    v_add_f32 v32, v32, v32 row_ror:8
    v_add_f32 v33, v33, v33 row_ror:8
    v_mfma_f32_16x16x32_bf16 v[100:103], v[84:87], v[164:167], v[100:103]
    v_add_f32 v34, v34, v34 row_ror:8
    v_add_f32 v35, v35, v35 row_ror:8
    v_mfma_f32_16x16x32_bf16 v[96:99], v[88:91], v[192:195], v[96:99]
    v_add_f32 v32, v32, v32 row_ror:4
    v_add_f32 v33, v33, v33 row_ror:4
    v_mfma_f32_16x16x32_bf16 v[100:103], v[88:91], v[196:199], v[100:103]
    v_add_f32 v34, v34, v34 row_ror:4
    v_add_f32 v35, v35, v35 row_ror:4
    v_mfma_f32_16x16x32_bf16 v[96:99], v[92:95], v[224:227], v[96:99]
    v_add_f32 v32, v32, v32 row_ror:2
    v_add_f32 v33, v33, v33 row_ror:2
    v_mfma_f32_16x16x32_bf16 v[100:103], v[92:95], v[228:231], v[100:103]
    v_add_f32 v34, v34, v34 row_ror:2
    v_add_f32 v35, v35, v35 row_ror:2
    v_mfma_f32_16x16x32_bf16 v[104:107], v[80:83], v[136:139], 0
    v_add_f32 v32, v32, v32 row_ror:1
    v_add_f32 v33, v33, v33 row_ror:1
    v_mfma_f32_16x16x32_bf16 v[108:111], v[80:83], v[140:143], 0
    v_add_f32 v34, v34, v34 row_ror:1
    v_add_f32 v35, v35, v35 row_ror:1
    v_mfma_f32_16x16x32_bf16 v[104:107], v[84:87], v[168:171], v[104:107]
    v_cvt_pk_bf16_f32 v16, v96, v100
    v_cvt_pk_bf16_f32 v20, v97, v101
    v_mfma_f32_16x16x32_bf16 v[108:111], v[84:87], v[172:175], v[108:111]
    v_cvt_pk_bf16_f32 v24, v98, v102
    v_cvt_pk_bf16_f32 v28, v99, v103
    v_mfma_f32_16x16x32_bf16 v[104:107], v[88:91], v[200:203], v[104:107]
    v_and_b32 v16, s60, v16
    v_and_b32 v20, s60, v20
    v_mfma_f32_16x16x32_bf16 v[108:111], v[88:91], v[204:207], v[108:111]
    v_and_b32 v24, s60, v24
    v_and_b32 v28, s60, v28
    v_mfma_f32_16x16x32_bf16 v[104:107], v[92:95], v[232:235], v[104:107]
    v_cvt_f16_f32 v32, v32
    v_cvt_f16_f32 v33, v33
    v_mfma_f32_16x16x32_bf16 v[108:111], v[92:95], v[236:239], v[108:111]
    v_cvt_f16_f32 v34, v34
    v_cvt_f16_f32 v35, v35
    v_mfma_f32_16x16x32_bf16 v[112:115], v[80:83], v[144:147], 0
    v_and_or_b32 v32, v32, s42, v36
    v_and_or_b32 v33, v33, s42, v37
    v_mfma_f32_16x16x32_bf16 v[116:119], v[80:83], v[148:151], 0
    v_and_or_b32 v34, v34, s42, v38
    v_and_or_b32 v35, v35, s42, v39
    v_mfma_f32_16x16x32_bf16 v[112:115], v[84:87], v[176:179], v[112:115]
    v_lshrrev_b32 v32, v1, v32
    v_lshrrev_b32 v33, v1, v33
    v_mfma_f32_16x16x32_bf16 v[116:119], v[84:87], v[180:183], v[116:119]
    v_lshrrev_b32 v34, v1, v34
    v_lshrrev_b32 v35, v1, v35
    v_mfma_f32_16x16x32_bf16 v[112:115], v[88:91], v[208:211], v[112:115]
    v_cvt_pk_bf16_f32 v17, v104, v108
    v_cvt_pk_bf16_f32 v21, v105, v109
    v_mfma_f32_16x16x32_bf16 v[116:119], v[88:91], v[212:215], v[116:119]
    v_cvt_pk_bf16_f32 v25, v106, v110
    v_cvt_pk_bf16_f32 v29, v107, v111
    v_mfma_f32_16x16x32_bf16 v[112:115], v[92:95], v[240:243], v[112:115]
    v_bfi_b32 v17, s59, v32, v17
    v_bfi_b32 v21, s59, v33, v21
    v_mfma_f32_16x16x32_bf16 v[116:119], v[92:95], v[244:247], v[116:119]
    v_bfi_b32 v25, s59, v34, v25
    v_bfi_b32 v29, s59, v35, v29
    v_mfma_f32_16x16x32_bf16 v[120:123], v[80:83], v[152:155], 0
    v_add_u32 v44, v16, v17
    v_add_u32 v45, v20, v21
    v_mfma_f32_16x16x32_bf16 v[124:127], v[80:83], v[156:159], 0
    v_add_u32 v46, v24, v25
    v_add_u32 v47, v28, v29
    v_mfma_f32_16x16x32_bf16 v[120:123], v[84:87], v[184:187], v[120:123]
    v_add_u32 v44, v44, v44 row_ror:8
    v_add_u32 v45, v45, v45 row_ror:8
    v_mfma_f32_16x16x32_bf16 v[124:127], v[84:87], v[188:191], v[124:127]
    v_add_u32 v46, v46, v46 row_ror:8
    v_add_u32 v47, v47, v47 row_ror:8
    v_mfma_f32_16x16x32_bf16 v[120:123], v[88:91], v[216:219], v[120:123]
    v_add_u32 v44, v44, v44 row_ror:4
    v_add_u32 v45, v45, v45 row_ror:4
    v_mfma_f32_16x16x32_bf16 v[124:127], v[88:91], v[220:223], v[124:127]
    v_add_u32 v46, v46, v46 row_ror:4
    v_add_u32 v47, v47, v47 row_ror:4
    v_mfma_f32_16x16x32_bf16 v[120:123], v[92:95], v[248:251], v[120:123]
    v_add_u32 v44, v44, v44 row_ror:2
    v_add_u32 v45, v45, v45 row_ror:2
    v_mfma_f32_16x16x32_bf16 v[124:127], v[92:95], v[252:255], v[124:127]
    v_add_u32 v46, v46, v46 row_ror:2
    v_add_u32 v47, v47, v47 row_ror:2
    v_add_u32 v44, v44, v44 row_ror:1
    v_add_u32 v45, v45, v45 row_ror:1
    v_add_u32 v46, v46, v46 row_ror:1
    v_add_u32 v47, v47, v47 row_ror:1
    v_cvt_pk_bf16_f32 v18, v112, v116
    v_cvt_pk_bf16_f32 v22, v113, v117
    v_cvt_pk_bf16_f32 v26, v114, v118
    v_cvt_pk_bf16_f32 v30, v115, v119
    v_sub_u32 v44, s58, v44
    v_cvt_pk_bf16_f32 v19, v120, v124
    v_lshrrev_b32 v44, v1, v44
    v_and_or_b32 v16, v44, s59, v16
    s_cbranch_execz L_PVC_back
    global_store_dwordx4 v52, v[16:19], s[30:31] sc1
    v_sub_u32 v45, s58, v45
    v_cvt_pk_bf16_f32 v23, v121, v125
    v_lshrrev_b32 v45, v1, v45
    v_and_or_b32 v20, v45, s59, v20
    global_store_dwordx4 v53, v[20:23], s[30:31] sc1
    v_sub_u32 v46, s58, v46
    v_cvt_pk_bf16_f32 v27, v122, v126
    v_lshrrev_b32 v46, v1, v46
    v_and_or_b32 v24, v46, s59, v24
    global_store_dwordx4 v54, v[24:27], s[30:31] sc1
    v_sub_u32 v47, s58, v47
    v_cvt_pk_bf16_f32 v31, v123, v127
    v_lshrrev_b32 v47, v1, v47
    v_and_or_b32 v28, v47, s59, v28
    global_store_dwordx4 v55, v[28:31], s[30:31] sc1
    s_mov_b64 exec, 1
    ds_add_u32 v13, v14 offset:16
    s_mov_b64 exec, -1
    s_waitcnt vmcnt(0)
    s_mov_b64 exec, 1
    ds_add_u32 v13, v14 offset:20
    s_mov_b64 exec, -1
L_PV_end:
    s_waitcnt lgkmcnt(0)
    s_endpgm
L_S:
    s_load_dwordx8 s[20:27], s[0:1], 64
    v_and_b32 v0, 63, v0
    v_and_b32 v1, 15, v0
    v_lshrrev_b32 v2, 4, v0
    v_lshlrev_b32 v3, 4, v0
    s_and_b32 s32, s2, 7
    s_lshr_b32 s33, s2, 3
    s_lshr_b32 s3, s3, 1
    s_lshr_b32 s35, s33, 4
    s_xor_b32 s35, s35, 1
    s_and_b32 s42, s33, 15
    s_lshl4_add_u32 s36, s32, s42
    s_and_b32 s47, s3, 3
    v_mov_b32 v13, 158720
    v_mov_b32 v14, 1
    s_mov_b32 s34, 0x1000000
    s_lshl_b32 s42, s36, 17
    s_lshl_b32 s43, s47, 15
    s_add_u32 s42, s42, s43
    s_lshl_b32 s43, s47, 8
    s_add_u32 s42, s42, s43
    v_lshlrev_b32 v4, 1, v2
    v_xor_b32 v4, v4, v1
    v_lshlrev_b32 v4, 4, v4
    v_lshl_add_u32 v4, v2, 10, v4
    v_add_u32 v4, s42, v4
    v_xor_b32 v26, 0x80, v4
    v_add_u32 v26, 4096, v26
    s_mul_i32 s43, s47, 40960
    s_mov_b32 m0, s43
    s_mov_b32 s44, 8192
    s_mov_b32 s59, s47
    s_lshr_b32 s38, s33, 3
    s_lshl2_add_u32 s38, s32, s38
    s_and_b32 s39, s33, 3
    s_bfe_u32 s40, s33, 0x10002
    v_and_b32 v5, 7, v1
    v_lshlrev_b32 v5, 1, v5
    v_xor_b32 v5, v5, v2
    v_lshlrev_b32 v5, 4, v5
    v_lshl_add_u32 v5, v1, 8, v5
    s_lshl_b32 s43, s47, 13
    v_add_u32 v5, s43, v5
    v_lshl_add_u32 v27, s47, 2, v13
    s_lshr_b32 s42, s47, 1
    s_lshl1_add_u32 s42, s39, s42
    s_lshl_b32 s42, s42, 19
    s_and_b32 s45, s47, 1
    s_lshl_b32 s45, s45, 16
    s_add_u32 s42, s42, s45
    s_lshl1_add_u32 s45, s38, s40
    s_lshl_b32 s43, s45, 7
    s_add_u32 s42, s42, s43
    v_lshrrev_b32 v8, 3, v0
    v_lshlrev_b32 v8, 13, v8
    v_and_b32 v9, 7, v0
    v_lshl_add_u32 v8, v9, 4, v8
    v_add_u32 v8, s42, v8
    s_waitcnt lgkmcnt(0)
    s_load_dword s41, s[30:31], 0
    s_waitcnt lgkmcnt(0)
    s_barrier
    s_lshl_b32 s42, s45, 16
    s_lshl_b32 s43, s47, 8
    s_add_u32 s42, s42, s43
    v_lshlrev_b32 v34, 12, v2
    v_lshl_add_u32 v34, v1, 4, v34
    v_add_u32 v34, s42, v34
    s_add_u32 s42, s39, 0
    s_and_b32 s42, s42, 3
    s_lshl_b32 s42, s42, 14
    v_add_u32 v28, s42, v34
    s_add_u32 s42, s39, 1
    s_and_b32 s42, s42, 3
    s_lshl_b32 s42, s42, 14
    v_add_u32 v29, s42, v34
    s_add_u32 s42, s39, 2
    s_and_b32 s42, s42, 3
    s_lshl_b32 s42, s42, 14
    v_add_u32 v30, s42, v34
    s_add_u32 s42, s39, 3
    s_and_b32 s42, s42, 3
    s_lshl_b32 s42, s42, 14
    v_add_u32 v31, s42, v34
    v_and_b32 v9, 1, v1
    v_lshlrev_b32 v9, 4, v9
    v_mov_b32 v10, 0xffff
    v_lshlrev_b32 v10, v9, v10
    v_bfe_u32 v9, v1, 1, 2
    v_cmp_eq_u32 vcc, 0, v9
    s_nop 1
    v_cndmask_b32 v36, 0, v10, vcc
    v_cmp_eq_u32 vcc, 1, v9
    s_nop 1
    v_cndmask_b32 v37, 0, v10, vcc
    v_cmp_eq_u32 vcc, 2, v9
    s_nop 1
    v_cndmask_b32 v38, 0, v10, vcc
    v_cmp_eq_u32 vcc, 3, v9
    s_nop 1
    v_cndmask_b32 v39, 0, v10, vcc
    global_load_lds_dwordx4 v4, s[6:7] nt
    v_add_u32 v4, s44, v4
    s_add_u32 m0, m0, 0x400
    v_lshlrev_b32 v10, 4, v1
    v_add_u32 v10, 152576, v10
    s_lshl_b32 s42, s47, 2
    v_add_u32 v9, s42, v10
    s_lshl_b32 s42, s47, 10
    s_add_u32 s42, s42, 147456
    v_add_u32 v11, s42, v3
    v_lshlrev_b32 v33, 2, v1
    v_add_u32 v33, 152832, v33
    s_lshl_b32 s42, s47, 8
    s_add_u32 s42, s42, 157696
    v_lshl_add_u32 v32, v0, 2, s42
    v_xor_b32 v6, v1, v2
    v_lshlrev_b32 v6, 4, v6
    v_lshl_add_u32 v6, v2, 8, v6
    s_add_u32 s42, s47, 0
    s_and_b32 s42, s42, 3
    s_lshl_b32 s42, s42, 12
    s_add_u32 s42, s42, 131072
    v_add_u32 v80, s42, v6
    v_xor_b32 v81, 64, v80
    s_add_u32 s42, s47, 1
    s_and_b32 s42, s42, 3
    s_lshl_b32 s42, s42, 12
    s_add_u32 s42, s42, 131072
    v_add_u32 v82, s42, v6
    v_xor_b32 v83, 64, v82
    s_add_u32 s42, s47, 2
    s_and_b32 s42, s42, 3
    s_lshl_b32 s42, s42, 12
    s_add_u32 s42, s42, 131072
    v_add_u32 v84, s42, v6
    v_xor_b32 v85, 64, v84
    s_add_u32 s42, s47, 3
    s_and_b32 s42, s42, 3
    s_lshl_b32 s42, s42, 12
    s_add_u32 s42, s42, 131072
    v_add_u32 v86, s42, v6
    v_xor_b32 v87, 64, v86
    s_bfe_u32 s42, s2, 0x20004
    s_and_b32 s43, s2, 3
    s_lshl2_add_u32 s42, s42, s43
    s_lshl_b32 s42, s42, 6
    s_bfe_u32 s43, s2, 0x10002
    s_lshl3_add_u32 s42, s43, s42
    s_bfe_u32 s43, s2, 0x10003
    s_lshl2_add_u32 s42, s43, s42
    v_and_b32 v35, 3, v0
    v_lshl_add_u32 v12, v35, 4, s42
    s_mov_b32 s58, 0x20000
    s_lshr_b32 s43, s2, 6
    s_lshl_b32 s43, s43, 10
    s_add_u32 s42, s42, s43
    s_cmp_lt_u32 s2, 224
    s_cselect_b32 s37, -1, 0
    s_cselect_b32 s43, 0, 512
    s_sub_u32 s42, s42, s43
    s_lshl1_add_u32 s42, s42, s47
    s_lshl_b32 s42, s42, 8
    v_lshlrev_b32 v34, 13, v2
    v_lshl_add_u32 v34, v1, 4, v34
    v_add_u32 v34, s42, v34
    s_bfe_u32 s42, s2, 0x20003
    s_and_b32 s43, s2, 3
    s_lshl2_add_u32 s42, s42, s43
    s_lshl_b32 s42, s42, 6
    s_bfe_u32 s43, s2, 0x10002
    s_lshl3_add_u32 s42, s43, s42
    v_lshl_add_u32 v12, v35, 4, s42
    v_and_b32 v6, 4, v0
    v_add_u32 v12, v6, v12
    global_load_dword v6, v12, s[4:5]
    global_load_dword v7, v12, s[24:25]
    s_mov_b64 exec, 0
    s_branch L_SM_nb
L_SM_back:
    s_mov_b64 exec, -1
    s_mov_b64 vcc, -1
    global_load_lds_dwordx4 v26, s[6:7] nt
    v_add_u32 v26, s44, v26
    s_add_u32 m0, m0, 0x400
    s_waitcnt vmcnt(1)
    global_load_lds_dwordx4 v4, s[6:7] nt
    v_add_u32 v4, s44, v4
    s_add_u32 m0, m0, 0x400
    s_cbranch_vccz L_dy_23
    ds_read_b32 v15, v13 offset:8
    s_waitcnt vmcnt(5) lgkmcnt(0)
    v_cmp_eq_u32 vcc, 0, v15
L_dy_23:
    global_load_lds_dwordx4 v26, s[6:7] nt
    v_add_u32 v26, s44, v26
    s_add_u32 m0, m0, 0x400
    s_cbranch_vccz L_dy_24
    ds_read_b32 v15, v13 offset:8
    s_waitcnt vmcnt(5) lgkmcnt(0)
    v_cmp_eq_u32 vcc, 0, v15
L_dy_24:
    global_load_lds_dwordx4 v4, s[6:7] nt
    v_add_u32 v4, s44, v4
    s_add_u32 m0, m0, 0x400
    s_cbranch_vccz L_dy_25
    ds_read_b32 v15, v13 offset:8
    s_waitcnt vmcnt(5) lgkmcnt(0)
    v_cmp_eq_u32 vcc, 0, v15
L_dy_25:
    global_load_lds_dwordx4 v26, s[6:7] nt
    s_lshl_b32 s60, s59, 8
    s_add_u32 s59, s59, 1
    s_and_b32 s59, s59, 3
    s_lshl_b32 s42, s59, 8
    s_sub_u32 s60, s42, s60
    s_sub_u32 s60, s60, 24576
    v_add_u32 v26, s44, v26
    s_add_u32 m0, m0, 0x400
    s_cbranch_vccz L_dy_26
    ds_read_b32 v15, v13 offset:8
    s_waitcnt vmcnt(5) lgkmcnt(0)
    v_cmp_eq_u32 vcc, 0, v15
L_dy_26:
    global_load_lds_dwordx4 v4, s[6:7] nt
    v_add_u32 v4, s60, v4
    s_add_u32 m0, m0, 0x400
    s_cbranch_vccz L_dy_27
    ds_read_b32 v15, v13 offset:8
    s_waitcnt vmcnt(5) lgkmcnt(0)
    v_cmp_eq_u32 vcc, 0, v15
L_dy_27:
    global_load_lds_dwordx4 v26, s[6:7] nt
    v_add_u32 v26, s60, v26
    s_lshl2_add_u32 s42, s59, s47
    s_lshl_b32 m0, s42, 13
    s_cbranch_vccz L_dy_28
    ds_read_b32 v15, v13 offset:8
    s_waitcnt vmcnt(5) lgkmcnt(0)
    v_cmp_eq_u32 vcc, 0, v15
L_dy_28:
    global_load_lds_dwordx4 v4, s[6:7] nt
    v_add_u32 v4, s44, v4
    s_add_u32 m0, m0, 0x400
    s_cbranch_vccz L_dy_29
    ds_read_b32 v15, v13 offset:8
    s_waitcnt vmcnt(5) lgkmcnt(0)
    v_cmp_eq_u32 vcc, 0, v15
L_dy_29:
    global_load_lds_dwordx4 v26, s[6:7] nt
    v_add_u32 v26, s44, v26
    s_add_u32 m0, m0, 0x400
    s_cbranch_vccz L_dy_30
    ds_read_b32 v15, v13 offset:8
    s_waitcnt vmcnt(5) lgkmcnt(0)
    v_cmp_eq_u32 vcc, 0, v15
L_dy_30:
    global_load_lds_dwordx4 v4, s[6:7] nt
    v_add_u32 v4, s44, v4
    s_add_u32 m0, m0, 0x400
    s_cbranch_vccz L_dy_31
    ds_read_b32 v15, v13 offset:8
    s_waitcnt vmcnt(5) lgkmcnt(0)
    v_cmp_eq_u32 vcc, 0, v15
L_dy_31:
    s_waitcnt vmcnt(10)
    global_load_lds_dwordx4 v26, s[6:7] nt
    v_add_u32 v26, s44, v26
    s_add_u32 m0, m0, 0x400
    s_cbranch_vccz L_dy_32
    ds_read_b32 v15, v13 offset:8
    s_waitcnt vmcnt(5) lgkmcnt(0)
    v_cmp_eq_u32 vcc, 0, v15
L_dy_32:
    s_waitcnt vmcnt(10)
    global_load_lds_dwordx4 v4, s[6:7] nt
    v_add_u32 v4, s44, v4
    s_add_u32 m0, m0, 0x400
    s_cbranch_vccz L_dy_33
    ds_read_b32 v15, v13 offset:8
    s_waitcnt vmcnt(5) lgkmcnt(0)
    v_cmp_eq_u32 vcc, 0, v15
L_dy_33:
    s_waitcnt vmcnt(10)
    global_load_lds_dwordx4 v26, s[6:7] nt
    s_lshl_b32 s60, s59, 8
    s_add_u32 s59, s59, 1
    s_and_b32 s59, s59, 3
    s_lshl_b32 s42, s59, 8
    s_sub_u32 s60, s42, s60
    s_sub_u32 s60, s60, 24576
    v_add_u32 v26, s44, v26
    s_add_u32 m0, m0, 0x400
    s_cbranch_vccz L_dy_34
    ds_read_b32 v15, v13 offset:8
    s_waitcnt vmcnt(5) lgkmcnt(0)
    v_cmp_eq_u32 vcc, 0, v15
L_dy_34:
    s_waitcnt vmcnt(10)
    global_load_lds_dwordx4 v4, s[6:7] nt
    v_add_u32 v4, s60, v4
    s_add_u32 m0, m0, 0x400
    s_cbranch_vccz L_dy_35
    ds_read_b32 v15, v13 offset:8
    s_waitcnt vmcnt(5) lgkmcnt(0)
    v_cmp_eq_u32 vcc, 0, v15
L_dy_35:
    s_waitcnt vmcnt(10)
    global_load_lds_dwordx4 v26, s[6:7] nt
    v_add_u32 v26, s60, v26
    s_lshl2_add_u32 s42, s59, s47
    s_lshl_b32 m0, s42, 13
    s_cbranch_vccz L_dy_36
    ds_read_b32 v15, v13 offset:8
    s_waitcnt vmcnt(5) lgkmcnt(0)
    v_cmp_eq_u32 vcc, 0, v15
L_dy_36:
    s_waitcnt vmcnt(10)
    global_load_lds_dwordx4 v4, s[6:7] nt
    v_add_u32 v4, s44, v4
    s_add_u32 m0, m0, 0x400
    s_cbranch_vccz L_dy_37
    ds_read_b32 v15, v13 offset:8
    s_waitcnt vmcnt(5) lgkmcnt(0)
    v_cmp_eq_u32 vcc, 0, v15
L_dy_37:
    s_waitcnt vmcnt(10)
    global_load_lds_dwordx4 v26, s[6:7] nt
    v_add_u32 v26, s44, v26
    s_add_u32 m0, m0, 0x400
    s_cbranch_vccz L_dy_38
    ds_read_b32 v15, v13 offset:8
    s_waitcnt vmcnt(5) lgkmcnt(0)
    v_cmp_eq_u32 vcc, 0, v15
L_dy_38:
    s_waitcnt vmcnt(10)
    s_mov_b64 exec, 1
    ds_add_u32 v27, v14 offset:32
    s_mov_b64 exec, -1
    s_add_u32 s43, s47, 0
    s_and_b32 s43, s43, 3
    s_lshl_b32 s43, s43, 15
    v_add_u32 v16, s43, v5
    v_xor_b32 v17, 64, v16
    v_xor_b32 v18, 128, v16
    v_xor_b32 v19, 192, v16
    ds_read_b128 v[128:131], v16 offset:0
    ds_read_b128 v[132:135], v16 offset:4096
    ds_read_b128 v[136:139], v17 offset:0
    ds_read_b128 v[140:143], v17 offset:4096
    ds_read_b128 v[144:147], v18 offset:0
    ds_read_b128 v[148:151], v18 offset:4096
    ds_read_b128 v[152:155], v19 offset:0
    ds_read_b128 v[156:159], v19 offset:4096
    global_load_lds_dwordx4 v4, s[6:7] nt
    v_add_u32 v4, s44, v4
    s_add_u32 m0, m0, 0x400
    s_cbranch_vccz L_dy_39
    ds_read_b32 v15, v13 offset:8
    s_waitcnt vmcnt(5) lgkmcnt(0)
    v_cmp_eq_u32 vcc, 0, v15
L_dy_39:
    s_waitcnt vmcnt(10)
    global_load_lds_dwordx4 v26, s[6:7] nt
    v_add_u32 v26, s44, v26
    s_add_u32 m0, m0, 0x400
    s_cbranch_vccz L_dy_40
    ds_read_b32 v15, v13 offset:8
    s_waitcnt vmcnt(5) lgkmcnt(0)
    v_cmp_eq_u32 vcc, 0, v15
L_dy_40:
    s_waitcnt vmcnt(10)
    global_load_lds_dwordx4 v4, s[6:7] nt
    v_add_u32 v4, s44, v4
    s_add_u32 m0, m0, 0x400
    s_cbranch_vccz L_dy_41
    ds_read_b32 v15, v13 offset:8
    s_waitcnt vmcnt(5) lgkmcnt(0)
    v_cmp_eq_u32 vcc, 0, v15
L_dy_41:
    s_waitcnt vmcnt(10)
    global_load_lds_dwordx4 v26, s[6:7] nt
    s_lshl_b32 s60, s59, 8
    s_add_u32 s59, s59, 1
    s_and_b32 s59, s59, 3
    s_lshl_b32 s42, s59, 8
    s_sub_u32 s60, s42, s60
    s_sub_u32 s60, s60, 24576
    v_add_u32 v26, s44, v26
    s_add_u32 m0, m0, 0x400
    s_mov_b64 exec, 1
    ds_add_u32 v13, v14 offset:4
    s_mov_b64 exec, -1
    s_cbranch_vccz L_dy_42
    ds_read_b32 v15, v13 offset:8
    s_waitcnt vmcnt(5) lgkmcnt(0)
    v_cmp_eq_u32 vcc, 0, v15
L_dy_42:
    s_waitcnt vmcnt(10)
    global_load_lds_dwordx4 v4, s[6:7] nt
    v_add_u32 v4, s60, v4
    s_add_u32 m0, m0, 0x400
    s_cbranch_vccz L_dy_43
    ds_read_b32 v15, v13 offset:8
    s_waitcnt vmcnt(5) lgkmcnt(0)
    v_cmp_eq_u32 vcc, 0, v15
L_dy_43:
    s_waitcnt vmcnt(10)
    global_load_lds_dwordx4 v26, s[6:7] nt
    v_add_u32 v26, s60, v26
    s_lshl2_add_u32 s42, s59, s47
    s_lshl_b32 m0, s42, 13
    s_cbranch_vccz L_dy_44
    ds_read_b32 v15, v13 offset:8
    s_waitcnt vmcnt(5) lgkmcnt(0)
    v_cmp_eq_u32 vcc, 0, v15
L_dy_44:
    s_waitcnt vmcnt(10)
    global_load_lds_dwordx4 v4, s[6:7] nt
    v_add_u32 v4, s44, v4
    s_add_u32 m0, m0, 0x400
    s_cbranch_vccz L_dy_45
    ds_read_b32 v15, v13 offset:8
    s_waitcnt vmcnt(5) lgkmcnt(0)
    v_cmp_eq_u32 vcc, 0, v15
L_dy_45:
    s_waitcnt vmcnt(10)
    global_load_lds_dwordx4 v26, s[6:7] nt
    v_add_u32 v26, s44, v26
    s_add_u32 m0, m0, 0x400
    s_cbranch_vccz L_dy_46
    ds_read_b32 v15, v13 offset:8
    s_waitcnt vmcnt(5) lgkmcnt(0)
    v_cmp_eq_u32 vcc, 0, v15
L_dy_46:
    s_waitcnt vmcnt(10)
    s_mov_b64 exec, 1
    ds_add_u32 v27, v14 offset:32
    s_mov_b64 exec, -1
    s_add_u32 s43, s47, 1
    s_and_b32 s43, s43, 3
    s_lshl_b32 s43, s43, 15
    v_add_u32 v16, s43, v5
    v_xor_b32 v17, 64, v16
    v_xor_b32 v18, 128, v16
    v_xor_b32 v19, 192, v16
    ds_read_b128 v[160:163], v16 offset:0
    ds_read_b128 v[164:167], v16 offset:4096
    ds_read_b128 v[168:171], v17 offset:0
    ds_read_b128 v[172:175], v17 offset:4096
    ds_read_b128 v[176:179], v18 offset:0
    ds_read_b128 v[180:183], v18 offset:4096
    ds_read_b128 v[184:187], v19 offset:0
    ds_read_b128 v[188:191], v19 offset:4096
    global_load_lds_dwordx4 v4, s[6:7] nt
    v_add_u32 v4, s44, v4
    s_add_u32 m0, m0, 0x400
    s_cbranch_vccz L_dy_47
    ds_read_b32 v15, v13 offset:8
    s_waitcnt vmcnt(5) lgkmcnt(0)
    v_cmp_eq_u32 vcc, 0, v15
L_dy_47:
    s_waitcnt vmcnt(10)
    global_load_lds_dwordx4 v26, s[6:7] nt
    v_add_u32 v26, s44, v26
    s_add_u32 m0, m0, 0x400
    s_cbranch_vccz L_dy_48
    ds_read_b32 v15, v13 offset:8
    s_waitcnt vmcnt(5) lgkmcnt(0)
    v_cmp_eq_u32 vcc, 0, v15
L_dy_48:
    s_waitcnt vmcnt(10)
    global_load_lds_dwordx4 v4, s[6:7] nt
    v_add_u32 v4, s44, v4
    s_add_u32 m0, m0, 0x400
    s_cbranch_vccz L_dy_49
    ds_read_b32 v15, v13 offset:8
    s_waitcnt vmcnt(5) lgkmcnt(0)
    v_cmp_eq_u32 vcc, 0, v15
L_dy_49:
    s_waitcnt vmcnt(10)
    global_load_lds_dwordx4 v26, s[6:7] nt
    s_lshl_b32 s60, s59, 8
    s_add_u32 s59, s59, 1
    s_and_b32 s59, s59, 3
    s_lshl_b32 s42, s59, 8
    s_sub_u32 s60, s42, s60
    s_sub_u32 s60, s60, 24576
    v_add_u32 v26, s44, v26
    s_add_u32 m0, m0, 0x400
    s_cbranch_vccz L_dy_50
    ds_read_b32 v15, v13 offset:8
    s_waitcnt vmcnt(5) lgkmcnt(0)
    v_cmp_eq_u32 vcc, 0, v15
L_dy_50:
    s_waitcnt vmcnt(10)
    global_load_lds_dwordx4 v4, s[6:7] nt
    s_add_u32 m0, m0, 0x400
    s_cbranch_vccz L_dy_51
    ds_read_b32 v15, v13 offset:8
    s_waitcnt vmcnt(5) lgkmcnt(0)
    v_cmp_eq_u32 vcc, 0, v15
L_dy_51:
    s_waitcnt vmcnt(10)
    global_load_lds_dwordx4 v26, s[6:7] nt
    s_add_u32 s43, s47, 2
    s_and_b32 s43, s43, 3
    s_lshl_b32 s43, s43, 15
    v_add_u32 v16, s43, v5
    v_xor_b32 v17, 64, v16
    v_xor_b32 v18, 128, v16
    v_xor_b32 v19, 192, v16
    s_waitcnt lgkmcnt(0)
    s_add_u32 s41, s41, 1
    s_addc_u32 s41, s41, 0
    s_setprio 2
L_fw_52:
    ds_read_b32 v15, v13 offset:12
    s_sub_u32 s34, s34, 1
    s_waitcnt lgkmcnt(0)
    v_cmp_gt_u32 vcc, 2, v15
    s_cbranch_scc1 L_fwd_53
    s_cbranch_vccnz L_fw_52
L_fwd_53:
    s_max_i32 s34, s34, 0
    ds_read_b128 v[96:99], v80 offset:0
    ds_read_b128 v[100:103], v81 offset:1024
    ds_read_b128 v[104:107], v80 offset:2048
    ds_read_b128 v[108:111], v81 offset:3072
    ds_read_b128 v[112:115], v82 offset:0
    s_waitcnt lgkmcnt(4)
    v_mfma_f32_16x16x32_bf16 v[40:43], v[128:131], v[96:99], 0
    v_mfma_f32_16x16x32_bf16 v[44:47], v[132:135], v[96:99], 0
    ds_read_b128 v[116:119], v83 offset:1024
    s_waitcnt lgkmcnt(4)
    v_mfma_f32_16x16x32_bf16 v[40:43], v[136:139], v[100:103], v[40:43]
    v_mfma_f32_16x16x32_bf16 v[44:47], v[140:143], v[100:103], v[44:47]
    ds_read_b128 v[120:123], v82 offset:2048
    s_waitcnt lgkmcnt(4)
    v_mfma_f32_16x16x32_bf16 v[40:43], v[144:147], v[104:107], v[40:43]
    v_mfma_f32_16x16x32_bf16 v[44:47], v[148:151], v[104:107], v[44:47]
    ds_read_b128 v[124:127], v83 offset:3072
    s_waitcnt lgkmcnt(4)
    v_mfma_f32_16x16x32_bf16 v[40:43], v[152:155], v[108:111], v[40:43]
    v_mfma_f32_16x16x32_bf16 v[44:47], v[156:159], v[108:111], v[44:47]
    ds_read_b128 v[96:99], v84 offset:0
    s_waitcnt lgkmcnt(4)
    v_mfma_f32_16x16x32_bf16 v[40:43], v[160:163], v[112:115], v[40:43]
    v_mfma_f32_16x16x32_bf16 v[44:47], v[164:167], v[112:115], v[44:47]
    ds_read_b128 v[100:103], v85 offset:1024
    s_waitcnt lgkmcnt(4)
    v_mfma_f32_16x16x32_bf16 v[40:43], v[168:171], v[116:119], v[40:43]
    v_mfma_f32_16x16x32_bf16 v[44:47], v[172:175], v[116:119], v[44:47]
    ds_read_b128 v[104:107], v84 offset:2048
    s_waitcnt lgkmcnt(4)
    v_mfma_f32_16x16x32_bf16 v[40:43], v[176:179], v[120:123], v[40:43]
    v_mfma_f32_16x16x32_bf16 v[44:47], v[180:183], v[120:123], v[44:47]
    ds_read_b128 v[108:111], v85 offset:3072
    s_waitcnt lgkmcnt(4)
    v_mfma_f32_16x16x32_bf16 v[40:43], v[184:187], v[124:127], v[40:43]
    v_mfma_f32_16x16x32_bf16 v[44:47], v[188:191], v[124:127], v[44:47]
    s_waitcnt vmcnt(8)
    ds_read_b128 v[192:195], v16 offset:0
    ds_read_b128 v[196:199], v16 offset:4096
    ds_read_b128 v[200:203], v17 offset:0
    ds_read_b128 v[204:207], v17 offset:4096
    ds_read_b128 v[208:211], v18 offset:0
    ds_read_b128 v[212:215], v18 offset:4096
    ds_read_b128 v[216:219], v19 offset:0
    ds_read_b128 v[220:223], v19 offset:4096
    s_mov_b64 exec, 1
    ds_add_u32 v27, v14 offset:32
    s_mov_b64 exec, -1
    s_add_u32 s43, s47, 3
    s_and_b32 s43, s43, 3
    s_lshl_b32 s43, s43, 15
    v_add_u32 v16, s43, v5
    v_xor_b32 v17, 64, v16
    v_xor_b32 v18, 128, v16
    v_xor_b32 v19, 192, v16
    ds_read_b128 v[112:115], v86 offset:0
    s_waitcnt lgkmcnt(8)
    v_mfma_f32_16x16x32_bf16 v[40:43], v[192:195], v[96:99], v[40:43]
    v_mfma_f32_16x16x32_bf16 v[44:47], v[196:199], v[96:99], v[44:47]
    ds_read_b128 v[116:119], v87 offset:1024
    s_waitcnt lgkmcnt(7)
    v_mfma_f32_16x16x32_bf16 v[40:43], v[200:203], v[100:103], v[40:43]
    v_mfma_f32_16x16x32_bf16 v[44:47], v[204:207], v[100:103], v[44:47]
    ds_read_b128 v[120:123], v86 offset:2048
    s_waitcnt lgkmcnt(6)
    v_mfma_f32_16x16x32_bf16 v[40:43], v[208:211], v[104:107], v[40:43]
    v_mfma_f32_16x16x32_bf16 v[44:47], v[212:215], v[104:107], v[44:47]
    ds_read_b128 v[124:127], v87 offset:3072
    s_waitcnt lgkmcnt(5)
    v_mfma_f32_16x16x32_bf16 v[40:43], v[216:219], v[108:111], v[40:43]
    v_mfma_f32_16x16x32_bf16 v[44:47], v[220:223], v[108:111], v[44:47]
    s_waitcnt vmcnt(0)
    ds_read_b128 v[224:227], v16 offset:0
    ds_read_b128 v[228:231], v16 offset:4096
    ds_read_b128 v[232:235], v17 offset:0
    ds_read_b128 v[236:239], v17 offset:4096
    ds_read_b128 v[240:243], v18 offset:0
    ds_read_b128 v[244:247], v18 offset:4096
    ds_read_b128 v[248:251], v19 offset:0
    ds_read_b128 v[252:255], v19 offset:4096
    s_waitcnt lgkmcnt(6)
    v_mfma_f32_16x16x32_bf16 v[40:43], v[224:227], v[112:115], v[40:43]
    v_mfma_f32_16x16x32_bf16 v[44:47], v[228:231], v[112:115], v[44:47]
    global_load_dwordx4 v[64:67], v28, s[14:15] offset:0
    global_load_dwordx4 v[68:71], v28, s[14:15] offset:1024
    s_waitcnt lgkmcnt(4)
    v_mfma_f32_16x16x32_bf16 v[40:43], v[232:235], v[116:119], v[40:43]
    v_mfma_f32_16x16x32_bf16 v[44:47], v[236:239], v[116:119], v[44:47]
    global_load_dwordx4 v[72:75], v28, s[14:15] offset:2048
    global_load_dwordx4 v[76:79], v28, s[14:15] offset:3072
    s_waitcnt lgkmcnt(2)
    v_mfma_f32_16x16x32_bf16 v[40:43], v[240:243], v[120:123], v[40:43]
    v_mfma_f32_16x16x32_bf16 v[44:47], v[244:247], v[120:123], v[44:47]
    global_load_dwordx4 v[88:91], v34, s[22:23] offset:0 nt
    s_waitcnt lgkmcnt(0)
    v_mfma_f32_16x16x32_bf16 v[40:43], v[248:251], v[124:127], v[40:43]
    v_mfma_f32_16x16x32_bf16 v[44:47], v[252:255], v[124:127], v[44:47]
    global_load_dwordx4 v[92:95], v34, s[22:23] offset:1024 nt
L_SM:
    s_mov_b32 s45, 0xffff0000
    s_mov_b32 s42, 0x3db504f3
    s_mov_b32 s43, 0x3fb8aa3b
    s_nop 2
    v_max3_f32 v24, v40, v41, v42
    v_max3_f32 v25, v44, v45, v46
    v_max3_f32 v24, v24, v43, v47
    v_max_f32 v24, v24, v25
    ds_max_f32 v33, v24 offset:128
    v_cvt_pk_bf16_f32 v16, v40, v41
    v_cvt_pk_bf16_f32 v17, v42, v43
    v_cvt_pk_bf16_f32 v18, v44, v45
    v_cvt_pk_bf16_f32 v19, v46, v47
    v_lshlrev_b32 v40, 16, v16
    v_and_b32 v41, s45, v16
    v_lshlrev_b32 v42, 16, v17
    v_and_b32 v43, s45, v17
    v_lshlrev_b32 v44, 16, v18
    v_and_b32 v45, s45, v18
    v_lshlrev_b32 v46, 16, v19
    v_and_b32 v47, s45, v19
    s_waitcnt lgkmcnt(0)
    s_barrier
L_SM_nb:
    ds_read_b32 v24, v33 offset:128
    v_mul_f32 v40, s42, v40
    v_mul_f32 v41, s42, v41
    v_mul_f32 v42, s42, v42
    v_mul_f32 v43, s42, v43
    v_mul_f32 v44, s42, v44
    v_mul_f32 v45, s42, v45
    v_mul_f32 v46, s42, v46
    v_mul_f32 v47, s42, v47
    v_cvt_pk_bf16_f32 v16, v40, v41
    v_cvt_pk_bf16_f32 v17, v42, v43
    v_cvt_pk_bf16_f32 v18, v44, v45
    v_cvt_pk_bf16_f32 v19, v46, v47
    v_lshlrev_b32 v40, 16, v16
    v_and_b32 v41, s45, v16
    v_lshlrev_b32 v42, 16, v17
    v_and_b32 v43, s45, v17
    v_lshlrev_b32 v44, 16, v18
    v_and_b32 v45, s45, v18
    v_lshlrev_b32 v46, 16, v19
    v_and_b32 v47, s45, v19
    s_waitcnt lgkmcnt(0)
    v_cvt_pk_bf16_f32 v24, v24, v24
    v_and_b32 v24, s45, v24
    v_mul_f32 v24, s42, v24
    v_cvt_pk_bf16_f32 v24, v24, v24
    v_and_b32 v25, s45, v24
    v_mul_f32 v24, s43, v25
    ds_write_b32 v33, v25
    v_fma_f32 v40, v40, s43, -v24
    v_fma_f32 v41, v41, s43, -v24
    v_fma_f32 v42, v42, s43, -v24
    v_fma_f32 v43, v43, s43, -v24
    v_fma_f32 v44, v44, s43, -v24
    v_fma_f32 v45, v45, s43, -v24
    v_fma_f32 v46, v46, s43, -v24
    v_fma_f32 v47, v47, s43, -v24
    v_exp_f32 v40, v40
    v_exp_f32 v41, v41
    v_exp_f32 v42, v42
    v_exp_f32 v43, v43
    v_exp_f32 v44, v44
    v_exp_f32 v45, v45
    v_exp_f32 v46, v46
    v_exp_f32 v47, v47
    v_cvt_pk_bf16_f32 v16, v40, v41
    v_cvt_pk_bf16_f32 v17, v42, v43
    v_cvt_pk_bf16_f32 v18, v44, v45
    v_cvt_pk_bf16_f32 v19, v46, v47
    ds_write_b128 v11, v[16:19]
    s_mov_b32 s42, 0x3f803f80
    v_dot2_f32_bf16 v25, v16, s42, 0
    v_dot2_f32_bf16 v25, v17, s42, v25
    v_dot2_f32_bf16 v25, v18, s42, v25
    v_dot2_f32_bf16 v25, v19, s42, v25
    s_nop 2
    ds_write_b32 v32, v25
    s_cbranch_execz L_SM_back
    s_waitcnt lgkmcnt(0)
    s_barrier
    s_setprio 0
    v_mov_b32 v46, v6
    v_mov_b32 v47, v7
    v_lshlrev_b32 v10, 3, v0
    v_add_u32 v10, 157184, v10
    s_lshl2_add_u32 s42, s38, s39
    s_lshl2_add_u32 s42, s42, s47
    s_lshl_b32 s42, s42, 13
    s_add_u32 s42, s42, 2097152
    v_lshlrev_b32 v4, 11, v2
    v_lshl_add_u32 v4, v1, 4, v4
    v_add_u32 v4, s42, v4
    s_mul_i32 s59, s41, 3816266512
    s_add_u32 s59, s59, 4055616904
    s_mov_b32 s60, 65537
    s_lshl_b32 s42, s47, 2
    s_add_u32 s42, s42, 152576
    v_mov_b32 v7, s42
    v_mov_b32 v45, 152576
    s_lshl_b32 s42, s47, 4
    s_add_u32 s42, s42, 152592
    v_lshl_add_u32 v11, v2, 2, s42
    s_lshl_b32 s42, s47, 17
    s_lshl_b32 s43, s2, 6
    s_add_u32 s42, s42, s43
    s_add_u32 s42, s42, 724992
    v_lshrrev_b32 v44, 2, v0
    v_lshlrev_b32 v44, 14, v44
    v_and_b32 v16, 3, v0
    v_lshl_add_u32 v44, v16, 4, v44
    v_add_u32 v44, s42, v44
    v_and_b32 v16, 1, v2
    v_lshrrev_b32 v17, 1, v2
    s_lshl_b32 s42, s47, 9
    s_add_u32 s43, s42, 153088
    v_add_u32 v40, s43, v3
    s_add_u32 s43, s42, 155136
    v_and_b32 v42, 7, v0
    v_lshlrev_b32 v42, 5, v42
    v_lshl_add_u32 v42, v16, 4, v42
    v_lshl_add_u32 v42, v17, 8, v42
    v_add_u32 v42, s43, v42
    s_lshl_b32 s42, s47, 7
    s_add_u32 s42, s42, 153088
    v_lshrrev_b32 v41, 3, v0
    v_lshl_add_u32 v41, v41, 4, s42
    v_lshl_add_u32 v41, v35, 2, v41
    v_bfe_u32 v9, v0, 2, 1
    v_lshl_add_u32 v41, v9, 10, v41
    v_lshl_add_u32 v127, v9, 3, v35
    v_lshl_add_u32 v127, v127, 2, v45
    v_lshl_add_u32 v9, v9, 3, v45
    v_lshrrev_b32 v43, 2, v1
    v_add_u32 v43, s39, v43
    v_and_b32 v43, 3, v43
    v_lshlrev_b32 v43, 4, v43
    v_lshl_add_u32 v43, v2, 2, v43
    v_add_u32 v43, v43, v35
    v_lshlrev_b32 v43, 2, v43
    v_add_u32 v43, 155136, v43
    v_mov_b32 v33, s41
    v_cmp_gt_u32 s[50:51], v0, 31
    v_and_b32 v16, 1, v0
    v_cmp_eq_u32 s[52:53], 1, v16
    v_mov_b32 v20, 0
    v_mov_b32 v21, 0
    v_mov_b32 v22, 0
    v_mov_b32 v23, 0
    s_mov_b32 exec_hi, 0
    global_store_dwordx4 v44, v[20:23], s[30:31] sc1
    s_mov_b64 exec, -1
    s_lshl_b32 s42, s47, 8
    s_sub_u32 s42, s2, s42
    s_cmp_lt_i32 s42, 224
    s_cbranch_scc1 L_nopwo
    s_mov_b64 exec, 0xff
    global_store_dword v12, v20, s[26:27] sc1
    s_mov_b64 exec, -1
L_nopwo:
L_fw_54:
    ds_read_b32 v15, v13 offset:16
    s_sub_u32 s34, s34, 1
    s_waitcnt lgkmcnt(0)
    v_cmp_gt_u32 vcc, 4, v15
    s_cbranch_scc1 L_fwd_55
    s_cbranch_vccnz L_fw_54
L_fwd_55:
    s_max_i32 s34, s34, 0
    global_load_dwordx4 v[48:51], v8, s[12:13] nt
    v_add_u32 v8, s58, v8
    global_load_dwordx4 v[52:55], v8, s[12:13] nt
    v_add_u32 v8, s58, v8
    global_load_dwordx4 v[56:59], v8, s[12:13] nt
    v_add_u32 v8, s58, v8
    global_load_dwordx4 v[60:63], v8, s[12:13] nt
L_fw_56:
    ds_read_b32 v15, v13 offset:20
    s_sub_u32 s34, s34, 1
    s_waitcnt lgkmcnt(0)
    v_cmp_gt_u32 vcc, 4, v15
    s_cbranch_scc1 L_fwd_57
    s_cbranch_vccnz L_fw_56
L_fwd_57:
    s_max_i32 s34, s34, 0
    s_waitcnt vmcnt(2)
L_nogate:
    global_load_dwordx4 v[176:179], v4, s[30:31] offset:0 sc1
    global_load_dwordx4 v[180:183], v4, s[30:31] offset:256 sc1
    global_load_dwordx4 v[184:187], v4, s[30:31] offset:512 sc1
    global_load_dwordx4 v[188:191], v4, s[30:31] offset:768 sc1
    global_load_dwordx4 v[192:195], v4, s[30:31] offset:1024 sc1
    global_load_dwordx4 v[196:199], v4, s[30:31] offset:1280 sc1
    global_load_dwordx4 v[200:203], v4, s[30:31] offset:1536 sc1
    global_load_dwordx4 v[204:207], v4, s[30:31] offset:1792 sc1
    v_mov_b64 v[250:251], v[66:67]
    v_mov_b64 v[66:67], v[68:69]
    v_mov_b64 v[68:69], v[250:251]
    v_mov_b64 v[250:251], v[74:75]
    v_mov_b64 v[74:75], v[76:77]
    v_mov_b64 v[76:77], v[250:251]
    v_mov_b64 v[250:251], v[90:91]
    v_mov_b64 v[90:91], v[92:93]
    v_mov_b64 v[92:93], v[250:251]
    v_or_b32 v248, v36, v38
    v_or_b32 v249, v37, v39
    v_and_b32 v16, 16, v0
    v_cmp_ne_u32 s[54:55], 0, v16
    s_waitcnt vmcnt(7)
    global_load_dwordx4 v[128:131], v29, s[14:15] offset:0
    global_load_dwordx4 v[132:135], v29, s[14:15] offset:1024
    v_and_b32 v19, s60, v176
    v_and_b32 v96, s60, v177
    v_xor_b32 v224, v19, v176
    v_lshl_add_u32 v19, v19, v1, v177
    v_xor_b32 v225, v96, v177
    v_lshlrev_b32 v96, v1, v96
    v_add3_u32 v32, v224, v19, 0
    s_waitcnt vmcnt(8)
    global_load_dwordx4 v[136:139], v29, s[14:15] offset:2048
    global_load_dwordx4 v[140:143], v29, s[14:15] offset:3072
    v_and_b32 v19, s60, v180
    v_and_b32 v97, s60, v181
    v_xor_b32 v226, v19, v180
    v_lshl_add_u32 v19, v19, v1, v181
    v_xor_b32 v227, v97, v181
    v_lshlrev_b32 v97, v1, v97
    v_add3_u32 v32, v226, v19, v32
    v_mov_b64 v[180:181], v[178:179]
    s_waitcnt vmcnt(9)
    global_load_dwordx4 v[144:147], v30, s[14:15] offset:0
    global_load_dwordx4 v[148:151], v30, s[14:15] offset:1024
    v_and_b32 v19, s60, v184
    v_and_b32 v98, s60, v185
    v_xor_b32 v228, v19, v184
    v_lshl_add_u32 v19, v19, v1, v185
    v_xor_b32 v229, v98, v185
    v_lshlrev_b32 v98, v1, v98
    v_add3_u32 v32, v228, v19, v32
    s_waitcnt vmcnt(10)
    global_load_dwordx4 v[152:155], v30, s[14:15] offset:2048
    global_load_dwordx4 v[156:159], v30, s[14:15] offset:3072
    v_and_b32 v19, s60, v188
    v_and_b32 v99, s60, v189
    v_xor_b32 v230, v19, v188
    v_lshl_add_u32 v19, v19, v1, v189
    v_xor_b32 v231, v99, v189
    v_lshlrev_b32 v99, v1, v99
    v_add3_u32 v32, v230, v19, v32
    v_mov_b64 v[188:189], v[186:187]
    s_waitcnt vmcnt(11)
    global_load_dwordx4 v[160:163], v31, s[14:15] offset:0
    v_and_b32 v19, s60, v192
    v_and_b32 v100, s60, v193
    v_xor_b32 v232, v19, v192
    v_lshl_add_u32 v19, v19, v1, v193
    v_xor_b32 v233, v100, v193
    v_lshlrev_b32 v100, v1, v100
    v_add3_u32 v32, v232, v19, v32
    s_waitcnt vmcnt(11)
    global_load_dwordx4 v[164:167], v31, s[14:15] offset:1024
    v_and_b32 v19, s60, v196
    v_and_b32 v101, s60, v197
    v_xor_b32 v234, v19, v196
    v_lshl_add_u32 v19, v19, v1, v197
    v_xor_b32 v235, v101, v197
    v_lshlrev_b32 v101, v1, v101
    v_add3_u32 v32, v234, v19, v32
    v_mov_b64 v[196:197], v[194:195]
    s_waitcnt vmcnt(11)
    global_load_dwordx4 v[168:171], v31, s[14:15] offset:2048
    v_and_b32 v19, s60, v200
    v_and_b32 v102, s60, v201
    v_xor_b32 v236, v19, v200
    v_lshl_add_u32 v19, v19, v1, v201
    v_xor_b32 v237, v102, v201
    v_lshlrev_b32 v102, v1, v102
    v_add3_u32 v32, v236, v19, v32
    s_waitcnt vmcnt(11)
    global_load_dwordx4 v[172:175], v31, s[14:15] offset:3072
    v_and_b32 v19, s60, v204
    v_and_b32 v103, s60, v205
    v_xor_b32 v238, v19, v204
    v_lshl_add_u32 v19, v19, v1, v205
    v_xor_b32 v239, v103, v205
    v_lshlrev_b32 v103, v1, v103
    v_add3_u32 v32, v238, v19, v32
    v_mov_b64 v[204:205], v[202:203]
    s_mov_b32 s46, 100000
L_T3_chk:
    v_or_b32 v20, v96, v96 row_ror:8 bank_mask:0x3
    v_or_b32 v21, v97, v97 row_ror:8 bank_mask:0x3
    v_or_b32 v22, v98, v98 row_ror:8 bank_mask:0x3
    v_or_b32 v23, v99, v99 row_ror:8 bank_mask:0x3
    v_add_u32 v32, v32, v32 row_ror:8
    v_or_b32 v20, v100, v100 row_ror:8 bank_mask:0xc
    v_or_b32 v21, v101, v101 row_ror:8 bank_mask:0xc
    v_or_b32 v22, v102, v102 row_ror:8 bank_mask:0xc
    v_or_b32 v23, v103, v103 row_ror:8 bank_mask:0xc
    v_add_u32 v32, v32, v32 row_ror:4
    v_or_b32 v24, v20, v20 row_shl:4 bank_mask:0x5
    v_or_b32 v25, v21, v21 row_shl:4 bank_mask:0x5
    s_nop 0
    v_or_b32 v24, v22, v22 row_shr:4 bank_mask:0xa
    v_or_b32 v25, v23, v23 row_shr:4 bank_mask:0xa
    v_add_u32 v32, v32, v32 row_ror:2
    v_or_b32 v24, v24, v24 quad_perm:[1,0,3,2]
    v_or_b32 v25, v25, v25 quad_perm:[1,0,3,2]
    v_add_u32 v32, v32, v32 row_ror:1
    v_or_b32 v24, v24, v24 quad_perm:[2,3,0,1]
    v_or_b32 v25, v25, v25 quad_perm:[2,3,0,1]
    v_cmp_ne_u32 vcc, s59, v32
    s_sub_u32 s46, s46, 1
    v_cndmask_b32 v5, v24, v25, s[52:53]
    s_cbranch_vccz L_T3_go
    s_cbranch_scc1 L_T3_go
    s_mov_b64 exec, vcc
    global_load_dwordx4 v[176:179], v4, s[30:31] offset:0 sc1
    global_load_dwordx4 v[180:183], v4, s[30:31] offset:256 sc1
    global_load_dwordx4 v[184:187], v4, s[30:31] offset:512 sc1
    global_load_dwordx4 v[188:191], v4, s[30:31] offset:768 sc1
    global_load_dwordx4 v[192:195], v4, s[30:31] offset:1024 sc1
    global_load_dwordx4 v[196:199], v4, s[30:31] offset:1280 sc1
    global_load_dwordx4 v[200:203], v4, s[30:31] offset:1536 sc1
    global_load_dwordx4 v[204:207], v4, s[30:31] offset:1792 sc1
    s_waitcnt vmcnt(7)
    v_and_b32 v19, s60, v176
    v_and_b32 v96, s60, v177
    v_xor_b32 v224, v19, v176
    v_lshl_add_u32 v19, v19, v1, v177
    v_xor_b32 v225, v96, v177
    v_lshlrev_b32 v96, v1, v96
    v_add3_u32 v32, v224, v19, 0
    s_waitcnt vmcnt(6)
    v_and_b32 v19, s60, v180
    v_and_b32 v97, s60, v181
    v_xor_b32 v226, v19, v180
    v_lshl_add_u32 v19, v19, v1, v181
    v_xor_b32 v227, v97, v181
    v_lshlrev_b32 v97, v1, v97
    v_add3_u32 v32, v226, v19, v32
    v_mov_b64 v[180:181], v[178:179]
    s_waitcnt vmcnt(5)
    v_and_b32 v19, s60, v184
    v_and_b32 v98, s60, v185
    v_xor_b32 v228, v19, v184
    v_lshl_add_u32 v19, v19, v1, v185
    v_xor_b32 v229, v98, v185
    v_lshlrev_b32 v98, v1, v98
    v_add3_u32 v32, v228, v19, v32
    s_waitcnt vmcnt(4)
    v_and_b32 v19, s60, v188
    v_and_b32 v99, s60, v189
    v_xor_b32 v230, v19, v188
    v_lshl_add_u32 v19, v19, v1, v189
    v_xor_b32 v231, v99, v189
    v_lshlrev_b32 v99, v1, v99
    v_add3_u32 v32, v230, v19, v32
    v_mov_b64 v[188:189], v[186:187]
    s_waitcnt vmcnt(3)
    v_and_b32 v19, s60, v192
    v_and_b32 v100, s60, v193
    v_xor_b32 v232, v19, v192
    v_lshl_add_u32 v19, v19, v1, v193
    v_xor_b32 v233, v100, v193
    v_lshlrev_b32 v100, v1, v100
    v_add3_u32 v32, v232, v19, v32
    s_waitcnt vmcnt(2)
    v_and_b32 v19, s60, v196
    v_and_b32 v101, s60, v197
    v_xor_b32 v234, v19, v196
    v_lshl_add_u32 v19, v19, v1, v197
    v_xor_b32 v235, v101, v197
    v_lshlrev_b32 v101, v1, v101
    v_add3_u32 v32, v234, v19, v32
    v_mov_b64 v[196:197], v[194:195]
    s_waitcnt vmcnt(1)
    v_and_b32 v19, s60, v200
    v_and_b32 v102, s60, v201
    v_xor_b32 v236, v19, v200
    v_lshl_add_u32 v19, v19, v1, v201
    v_xor_b32 v237, v102, v201
    v_lshlrev_b32 v102, v1, v102
    v_add3_u32 v32, v236, v19, v32
    s_waitcnt vmcnt(0)
    v_and_b32 v19, s60, v204
    v_and_b32 v103, s60, v205
    v_xor_b32 v238, v19, v204
    v_lshl_add_u32 v19, v19, v1, v205
    v_xor_b32 v239, v103, v205
    v_lshlrev_b32 v103, v1, v103
    v_add3_u32 v32, v238, v19, v32
    v_mov_b64 v[204:205], v[202:203]
    s_nop 0
    s_branch L_T3_chk
L_T3_go:
    s_mov_b64 exec, -1
    s_mov_b32 s43, 0x3fb8aa3b
    v_and_b32 v6, s45, v5
    v_cvt_f32_f16 v21, v5
    v_mul_f32 v6, s43, v6
    v_mul_f32 v21, 0.5, v21
    s_nop 0
    v_max_f32 v18, v6, v6 row_ror:8
    s_nop 1
    v_max_f32 v18, v18, v18 row_ror:4
    s_nop 1
    v_max_f32 v18, v18, v18 row_ror:1
    v_mov_b32 v19, v18
    s_nop 1
    v_permlane16_swap_b32 v19, v18
    v_max_f32 v18, v18, v19
    v_mov_b32 v19, v18
    s_nop 1
    v_permlane32_swap_b32 v19, v18
    v_max_f32 v18, v18, v19
    v_sub_f32 v17, v6, v18
    v_exp_f32 v17, v17
    s_nop 0
    v_cvt_pk_bf16_f32 v16, v17, v17
    v_mul_f32 v17, v17, v21
    s_nop 0
    v_and_b32 v208, v16, v248 row_newbcast:0
    v_and_b32 v209, v16, v249 row_newbcast:0
    v_and_b32 v210, v16, v248 row_newbcast:1
    v_and_b32 v211, v16, v249 row_newbcast:1
    v_and_b32 v212, v16, v248 row_newbcast:4
    v_and_b32 v213, v16, v249 row_newbcast:4
    v_mfma_f32_16x16x32_bf16 v[24:27], v[208:211], v[224:227], 0
    v_and_b32 v214, v16, v248 row_newbcast:5
    v_and_b32 v215, v16, v249 row_newbcast:5
    v_mfma_f32_16x16x32_bf16 v[20:23], v[208:211], v[180:183], 0
    v_add_f32 v17, v17, v17 row_ror:8
    v_and_b32 v208, v16, v248 row_newbcast:8
    v_and_b32 v209, v16, v249 row_newbcast:8
    v_mfma_f32_16x16x32_bf16 v[24:27], v[212:215], v[228:231], v[24:27]
    v_and_b32 v210, v16, v248 row_newbcast:9
    v_and_b32 v211, v16, v249 row_newbcast:9
    v_mfma_f32_16x16x32_bf16 v[20:23], v[212:215], v[188:191], v[20:23]
    v_add_f32 v17, v17, v17 row_ror:4
    v_and_b32 v212, v16, v248 row_newbcast:12
    v_and_b32 v213, v16, v249 row_newbcast:12
    v_mfma_f32_16x16x32_bf16 v[24:27], v[208:211], v[232:235], v[24:27]
    v_and_b32 v214, v16, v248 row_newbcast:13
    v_and_b32 v215, v16, v249 row_newbcast:13
    v_mfma_f32_16x16x32_bf16 v[20:23], v[208:211], v[196:199], v[20:23]
    v_add_f32 v17, v17, v17 row_ror:2
    s_nop 1
    v_add_f32 v17, v17, v17 row_ror:1
    v_mfma_f32_16x16x32_bf16 v[24:27], v[212:215], v[236:239], v[24:27]
    v_mfma_f32_16x16x32_bf16 v[20:23], v[212:215], v[204:207], v[20:23]
    ds_write_b32 v7, v18
    ds_write_b32 v11, v17
    s_mov_b64 exec, 0xffff
    s_nop 3
    ds_write_b128 v40, v[24:27]
    ds_write_b128 v40, v[20:23] offset:256
    s_mov_b64 exec, -1
    s_waitcnt lgkmcnt(0)
    s_barrier
    ds_read_b128 v[96:99], v45
    ds_read_b64 v[100:101], v9
    ds_read2st64_b32 v[108:109], v41 offset0:0 offset1:2
    ds_read2_b32 v[102:103], v127 offset0:4 offset1:8
    ds_read_b64 v[124:125], v10
    s_waitcnt vmcnt(8)
    v_mov_b64 v[250:251], v[130:131]
    v_mov_b64 v[130:131], v[132:133]
    v_mov_b64 v[132:133], v[250:251]
    v_mov_b64 v[250:251], v[138:139]
    v_mov_b64 v[138:139], v[140:141]
    v_mov_b64 v[140:141], v[250:251]
    s_waitcnt lgkmcnt(4)
    v_max3_f32 v18, v96, v97, v98
    v_max_f32 v18, v18, v99
    s_waitcnt lgkmcnt(2)
    v_sub_f32 v100, v100, v18
    v_sub_f32 v101, v101, v18
    v_exp_f32 v100, v100
    v_exp_f32 v101, v101
    v_mul_f32 v20, v100, v108
    v_fmac_f32 v20, v101, v109
    s_waitcnt lgkmcnt(0)
    v_mul_f32 v18, v100, v102
    v_add_f32 v21, v20, v20 row_shl:4 bank_mask:0x5
    v_fmac_f32 v18, v101, v103
    s_nop 0
    v_add_f32 v21, v20, v20 row_shr:4 bank_mask:0xa
    v_cvt_pk_bf16_f32 v20, v21, v21
    v_add_f32 v18, v18, v18 row_half_mirror
    s_nop 0
    v_and_b32 v208, v20, v36 quad_perm:[0,0,0,0]
    v_and_b32 v209, v20, v37 quad_perm:[0,0,0,0]
    v_and_b32 v210, v20, v38 quad_perm:[0,0,0,0]
    v_and_b32 v211, v20, v39 quad_perm:[0,0,0,0]
    v_and_b32 v212, v20, v36 quad_perm:[1,1,1,1]
    v_and_b32 v213, v20, v37 quad_perm:[1,1,1,1]
    v_and_b32 v214, v20, v38 quad_perm:[1,1,1,1]
    v_and_b32 v215, v20, v39 quad_perm:[1,1,1,1]
    v_mfma_f32_16x16x32_bf16 v[24:27], v[208:211], v[48:51], 0
    v_and_b32 v216, v20, v36 quad_perm:[2,2,2,2]
    v_and_b32 v217, v20, v37 quad_perm:[2,2,2,2]
    v_and_b32 v218, v20, v38 quad_perm:[2,2,2,2]
    v_and_b32 v219, v20, v39 quad_perm:[2,2,2,2]
    v_mfma_f32_16x16x32_bf16 v[24:27], v[212:215], v[52:55], v[24:27]
    v_and_b32 v220, v20, v36 quad_perm:[3,3,3,3]
    v_and_b32 v221, v20, v37 quad_perm:[3,3,3,3]
    v_and_b32 v222, v20, v38 quad_perm:[3,3,3,3]
    v_and_b32 v223, v20, v39 quad_perm:[3,3,3,3]
    v_add_f32 v18, v18, v18 quad_perm:[1,0,3,2]
    v_mfma_f32_16x16x32_bf16 v[24:27], v[216:219], v[56:59], v[24:27]
    s_nop 0
    v_add_f32 v18, v18, v18 quad_perm:[2,3,0,1]
    v_mfma_f32_16x16x32_bf16 v[24:27], v[220:223], v[60:63], v[24:27]
    v_rcp_f32 v18, v18
    v_and_b32 v124, s37, v124
    v_and_b32 v125, s37, v125
    v_and_b32 v224, v124, v248
    v_and_b32 v225, v124, v249
    v_and_b32 v226, v125, v248
    v_and_b32 v227, v125, v249
    s_mov_b32 exec_lo, 0x00ff00ff
    s_mov_b32 exec_hi, 0xff00ff00
    ds_write_b128 v42, v[24:27]
    s_mov_b64 exec, -1
    s_waitcnt vmcnt(4)
    v_mov_b64 v[250:251], v[146:147]
    v_mov_b64 v[146:147], v[148:149]
    v_mov_b64 v[148:149], v[250:251]
    v_mov_b64 v[250:251], v[154:155]
    v_mov_b64 v[154:155], v[156:157]
    v_mov_b64 v[156:157], v[250:251]
    s_waitcnt lgkmcnt(0)
    s_barrier
    ds_read2st64_b32 v[108:109], v43 offset0:0 offset1:1
    ds_read2st64_b32 v[110:111], v43 offset0:2 offset1:3
    ds_read2st64_b32 v[112:113], v43 offset0:4 offset1:5
    ds_read2st64_b32 v[114:115], v43 offset0:6 offset1:7
    v_mfma_f32_16x16x32_bf16 v[104:107], v[224:227], v[88:91], 0
    v_mfma_f32_16x16x32_bf16 v[116:119], v[224:227], v[92:95], 0
    v_mov_b32 v22, v33
    v_mov_b32 v23, v33
    s_waitcnt vmcnt(0)
    v_mov_b64 v[250:251], v[162:163]
    v_mov_b64 v[162:163], v[164:165]
    v_mov_b64 v[164:165], v[250:251]
    v_mov_b64 v[250:251], v[170:171]
    v_mov_b64 v[170:171], v[172:173]
    v_mov_b64 v[172:173], v[250:251]
    s_waitcnt lgkmcnt(2)
    v_add_f32 v108, v108, v109
    v_add_f32 v110, v110, v111
    s_waitcnt lgkmcnt(0)
    v_add_f32 v112, v112, v113
    v_add_f32 v114, v114, v115
    v_add_f32 v108, v108, v110
    v_add_f32 v112, v112, v114
    v_add_f32 v108, v108, v112
    v_mul_f32 v108, v108, v18
    v_cvt_pk_bf16_f32 v20, v108, v108
    s_nop 1
    v_and_b32 v240, v20, v248 row_newbcast:0
    v_and_b32 v241, v20, v249 row_newbcast:0
    v_and_b32 v242, v20, v248 row_newbcast:1
    v_and_b32 v243, v20, v249 row_newbcast:1
    v_and_b32 v244, v20, v248 row_newbcast:2
    v_and_b32 v245, v20, v249 row_newbcast:2
    v_mfma_f32_16x16x32_bf16 v[104:107], v[240:243], v[64:67], v[104:107]
    v_and_b32 v246, v20, v248 row_newbcast:3
    v_and_b32 v247, v20, v249 row_newbcast:3
    v_mfma_f32_16x16x32_bf16 v[116:119], v[240:243], v[68:71], v[116:119]
    v_and_b32 v240, v20, v248 row_newbcast:4
    v_and_b32 v241, v20, v249 row_newbcast:4
    v_mfma_f32_16x16x32_bf16 v[104:107], v[244:247], v[72:75], v[104:107]
    v_and_b32 v242, v20, v248 row_newbcast:5
    v_and_b32 v243, v20, v249 row_newbcast:5
    v_mfma_f32_16x16x32_bf16 v[116:119], v[244:247], v[76:79], v[116:119]
    v_and_b32 v244, v20, v248 row_newbcast:6
    v_and_b32 v245, v20, v249 row_newbcast:6
    v_mfma_f32_16x16x32_bf16 v[104:107], v[240:243], v[128:131], v[104:107]
    v_and_b32 v246, v20, v248 row_newbcast:7
    v_and_b32 v247, v20, v249 row_newbcast:7
    v_mfma_f32_16x16x32_bf16 v[116:119], v[240:243], v[132:135], v[116:119]
    v_and_b32 v240, v20, v248 row_newbcast:8
    v_and_b32 v241, v20, v249 row_newbcast:8
    v_mfma_f32_16x16x32_bf16 v[104:107], v[244:247], v[136:139], v[104:107]
    v_and_b32 v242, v20, v248 row_newbcast:9
    v_and_b32 v243, v20, v249 row_newbcast:9
    v_mfma_f32_16x16x32_bf16 v[116:119], v[244:247], v[140:143], v[116:119]
    v_and_b32 v244, v20, v248 row_newbcast:10
    v_and_b32 v245, v20, v249 row_newbcast:10
    v_mfma_f32_16x16x32_bf16 v[104:107], v[240:243], v[144:147], v[104:107]
    v_and_b32 v246, v20, v248 row_newbcast:11
    v_and_b32 v247, v20, v249 row_newbcast:11
    v_mfma_f32_16x16x32_bf16 v[116:119], v[240:243], v[148:151], v[116:119]
    v_and_b32 v240, v20, v248 row_newbcast:12
    v_and_b32 v241, v20, v249 row_newbcast:12
    v_mfma_f32_16x16x32_bf16 v[104:107], v[244:247], v[152:155], v[104:107]
    v_and_b32 v242, v20, v248 row_newbcast:13
    v_and_b32 v243, v20, v249 row_newbcast:13
    v_mfma_f32_16x16x32_bf16 v[116:119], v[244:247], v[156:159], v[116:119]
    v_and_b32 v244, v20, v248 row_newbcast:14
    v_and_b32 v245, v20, v249 row_newbcast:14
    v_mfma_f32_16x16x32_bf16 v[104:107], v[240:243], v[160:163], v[104:107]
    v_and_b32 v246, v20, v248 row_newbcast:15
    v_and_b32 v247, v20, v249 row_newbcast:15
    v_mfma_f32_16x16x32_bf16 v[116:119], v[240:243], v[164:167], v[116:119]
    s_nop 0
    v_mfma_f32_16x16x32_bf16 v[104:107], v[244:247], v[168:171], v[104:107]
    v_mfma_f32_16x16x32_bf16 v[116:119], v[244:247], v[172:175], v[116:119]
    s_mov_b32 s42, 0x07060501
    s_mov_b32 s43, 0x07060502
    s_mov_b32 s44, 0x07060503
    s_mov_b32 exec_hi, 0
    s_nop 3
    v_cndmask_b32 v19, v107, v119, s[54:55]
    v_cndmask_b32 v16, v104, v116, s[54:55]
    v_cndmask_b32 v17, v105, v117, s[54:55]
    v_cndmask_b32 v18, v106, v118, s[54:55]
    v_perm_b32 v20, v16, v19, s42
    v_perm_b32 v21, v17, v19, s43
    v_perm_b32 v22, v18, v19, s44
    global_store_dwordx4 v44, v[20:23], s[30:31] sc1
    s_mov_b64 exec, -1
    s_cmp_lt_u32 s2, 224
    s_cbranch_scc1 L_T_ep
    s_and_b32 s42, s2, 31
    s_lshl2_add_u32 s42, s42, s47
    s_lshl_b32 s42, s42, 12
    s_add_u32 s42, s42, 724992
    v_add_u32 v4, s42, v3
    v_lshl_add_u32 v8, v2, 2, v35
    s_lshl_b32 s42, s47, 2
    s_add_u32 s42, s42, 153088
    v_lshl_add_u32 v8, v8, 4, s42
    v_lshlrev_b32 v9, 4, v1
    v_add_u32 v9, 153088, v9
    v_lshlrev_b32 v108, 16, v46
    v_and_b32 v109, s45, v46
    v_lshlrev_b32 v110, 16, v47
    v_and_b32 v111, s45, v47
    v_add_f32 v108, v108, v110
    v_add_f32 v109, v109, v111
    s_mov_b32 s42, 0x0c04000c
    s_mov_b32 s43, 0x0402010c
    s_mov_b32 s46, 100000
    v_mov_b32 v108, v109 quad_perm:[0,1,2,3] bank_mask:0xc
    s_waitcnt vmcnt(0)
    global_load_dwordx4 v[128:131], v4, s[30:31] offset:0 sc1
    global_load_dwordx4 v[132:135], v4, s[30:31] offset:1024 sc1
    global_load_dwordx4 v[136:139], v4, s[30:31] offset:2048 sc1
    global_load_dwordx4 v[140:143], v4, s[30:31] offset:3072 sc1
L_T5_chk:
    s_sub_u32 s46, s46, 1
    s_waitcnt vmcnt(3)
    v_perm_b32 v16, v129, v128, s42
    v_xor_b32 v17, v131, v33
    v_perm_b32 v23, v130, v16, s43
    s_waitcnt vmcnt(2)
    v_perm_b32 v16, v133, v132, s42
    v_bitop3_b32 v17, v135, v33, v17 bitop3:0xbe
    v_perm_b32 v16, v134, v16, s43
    v_pk_add_f32 v[20:21], v[128:129], v[132:133]
    v_add_f32 v22, v130, v134
    v_add_f32 v23, v23, v16
    s_waitcnt vmcnt(1)
    v_perm_b32 v16, v137, v136, s42
    v_bitop3_b32 v17, v139, v33, v17 bitop3:0xbe
    v_perm_b32 v16, v138, v16, s43
    v_pk_add_f32 v[20:21], v[20:21], v[136:137]
    v_add_f32 v22, v22, v138
    v_add_f32 v23, v23, v16
    s_waitcnt vmcnt(0)
    v_perm_b32 v16, v141, v140, s42
    v_bitop3_b32 v17, v143, v33, v17 bitop3:0xbe
    v_perm_b32 v16, v142, v16, s43
    v_pk_add_f32 v[20:21], v[20:21], v[140:141]
    v_add_f32 v22, v22, v142
    v_add_f32 v23, v23, v16
    v_cmp_ne_u32 vcc, 0, v17
    s_cbranch_scc1 L_T5_go
    s_cbranch_vccz L_T5_go
    v_cmp_ne_u32 vcc, v131, v33
    s_nop 0
    s_cbranch_vccz L_r5_58
    s_mov_b64 exec, vcc
    global_load_dwordx4 v[128:131], v4, s[30:31] offset:0 sc1
    s_mov_b64 exec, -1
L_r5_58:
    v_cmp_ne_u32 vcc, v135, v33
    s_nop 0
    s_cbranch_vccz L_r5_59
    s_mov_b64 exec, vcc
    global_load_dwordx4 v[132:135], v4, s[30:31] offset:1024 sc1
    s_mov_b64 exec, -1
L_r5_59:
    v_cmp_ne_u32 vcc, v139, v33
    s_nop 0
    s_cbranch_vccz L_r5_60
    s_mov_b64 exec, vcc
    global_load_dwordx4 v[136:139], v4, s[30:31] offset:2048 sc1
    s_mov_b64 exec, -1
L_r5_60:
    v_cmp_ne_u32 vcc, v143, v33
    s_nop 0
    s_cbranch_vccz L_r5_61
    s_mov_b64 exec, vcc
    global_load_dwordx4 v[140:143], v4, s[30:31] offset:3072 sc1
    s_mov_b64 exec, -1
L_r5_61:
    s_waitcnt vmcnt(0)
    s_branch L_T5_chk
L_T5_go:
    v_permlane32_swap_b32 v20, v21
    v_permlane32_swap_b32 v22, v23
    v_add_f32 v20, v20, v21
    v_add_f32 v22, v22, v23
    s_nop 1
    v_permlane16_swap_b32 v20, v22
    v_add_f32 v20, v20, v22
    s_nop 1
    v_add_f32 v20, v20, v20 row_ror:4
    s_nop 1
    v_add_f32 v20, v20, v20 row_ror:8
    ds_write_b32 v8, v20
    s_waitcnt lgkmcnt(0)
    s_barrier
    s_cmp_lg_u32 s47, 0
    s_cbranch_scc1 L_T_done
    ds_read_b128 v[128:131], v9
    s_waitcnt lgkmcnt(0)
    v_add_f32 v128, v128, v129
    v_add_f32 v130, v130, v131
    v_add_f32 v108, v108, v128
    v_add_f32 v108, v108, v130
    s_nop 1
    v_mov_b32 v109, v108 row_ror:8
    v_cvt_pk_bf16_f32 v20, v108, v109
    s_mov_b64 exec, 0xff
    global_store_dword v12, v20, s[26:27] sc1
    s_branch L_T_done
L_T_ep:
    s_lshl2_add_u32 s42, s2, s47
    s_cmp_lg_u32 s42, 401
    s_cbranch_scc1 L_T_done
    v_mov_b32 v22, 0
    s_mov_b64 exec, 1
    global_store_dword v22, v33, s[30:31] sc1
L_T_done:
L_end:
    s_endpgm
.section .rodata,"a"
.p2align 6
.amdhsa_kernel parallel_sum__compressed_kv_cla__dense_activation_squared_relu__decode_kernel
  .amdhsa_next_free_vgpr 256
  .amdhsa_next_free_sgpr 102
  .amdhsa_accum_offset 256
  .amdhsa_group_segment_fixed_size 0
  .amdhsa_kernarg_size 112
  .amdhsa_user_sgpr_count 2
  .amdhsa_user_sgpr_kernarg_segment_ptr 1
  .amdhsa_system_sgpr_workgroup_id_x 1
.end_amdhsa_kernel
```
